```python
import torch

def _softmax(x, axis=-1):
    return torch.softmax(x, dim=axis)
def _gelu(x):
    return torch.nn.functional.gelu(x, approximate="tanh")
def _silu(x):
    return torch.nn.functional.silu(x)
def _sigmoid(x):
    return torch.sigmoid(x)
def _layernorm(x, axis=-1, eps=1e-5):
    m = x.mean(dim=axis, keepdim=True)
    v = x.var(dim=axis, keepdim=True, unbiased=False)
    return (x - m) / torch.sqrt(v + eps)
def _scatter_add(tgt, idx, src, axis=0):
    return tgt.clone().index_add_(axis, idx, src)
def _segment_sum(src, seg, n):
    out = torch.zeros((n,) + src.shape[1:], dtype=src.dtype)
    return out.index_add_(0, seg, src)
def _pad(x, pw):
    flat = tuple(v for pair in reversed(pw) for v in pair)
    return torch.nn.functional.pad(x, flat)

kernel_name = 'gated_mix__mha_block__linear_kernel_hedgehog__prompt'

def setup_inputs():

    _w = (lambda a: (lambda t: t.to(torch.bfloat16) if t.is_floating_point() else t)(torch.as_tensor(a)))
    def _A_setup():
        B, S, D, H = 1, 2048, 512, 32
        return {
            "x": _w((lambda *s: torch.randn(*s, dtype=torch.bfloat16) * 0.05)(B, S, D)),
            "wqkv": _w((lambda *s: torch.randn(*s, dtype=torch.bfloat16) * 0.8)(D, 3 * D)),
            "wo": _w((lambda *s: torch.randn(*s, dtype=torch.bfloat16) * 0.05)(D, D)),
        }
    _A_in = _A_setup()

    def _B_setup():
        B, S, D, H = 1, 2048, 512, 32
        Dh = D // H
        return {
            "x": _w((lambda *s: torch.randn(*s, dtype=torch.bfloat16) * 0.05)(B, S, D)),
            "wqkv": _w((lambda *s: torch.randn(*s, dtype=torch.bfloat16) * 1.6)(D, 3 * D)),
            "w_phi": _w((lambda *s: torch.randn(*s, dtype=torch.bfloat16) * 1.6)(H, Dh, Dh) * (Dh ** -0.5)),
            "wo": _w((lambda *s: torch.randn(*s, dtype=torch.bfloat16) * 0.05)(D, D)),
        }
    _B_in = _B_setup()

    return {
        "A_x": _A_in["x"],
        "A_wqkv": _A_in["wqkv"],
        "A_wo": _A_in["wo"],
        "B_x": _B_in["x"],
        "B_wqkv": _B_in["wqkv"],
        "B_w_phi": _B_in["w_phi"],
        "B_wo": _B_in["wo"],
        "gate_w": _w((lambda *s: torch.randn(*s, dtype=torch.bfloat16) * 0.05)(512) * 16.0),
    }

def reference(A_x, A_wqkv, A_wo, B_x, B_wqkv, B_w_phi, B_wo, gate_w):
    def _A_ref(x, wqkv, wo):
        B, S, D = x.shape
        H = 32
        Dh = D // H
        qkv = (lambda x, *d: x.permute(*d))((x @ wqkv).reshape(B, S, 3, H, Dh), 2, 0, 3, 1, 4)
        q, k, v = qkv[0], qkv[1], qkv[2]
        scores = torch.einsum("bhqd,bhkd->bhqk", q, k) * (Dh ** -0.5)
        p = _softmax(scores, axis=-1)
        o = torch.einsum("bhqk,bhkd->bhqd", p, v)
        return (lambda x, *d: x.permute(*d))(o, 0, 2, 1, 3).reshape(B, S, D) @ wo

    def _B_ref(x, wqkv, w_phi, wo):
        B, S, D = x.shape
        H = 32; Dh = D // H
        qkv = (lambda x, *d: x.permute(*d))((x @ wqkv).reshape(B, S, 3, H, Dh), 2, 0, 3, 1, 4)
        q, k, v = qkv[0], qkv[1], qkv[2]
        pq = torch.einsum("bhsd,hdf->bhsf", q, w_phi)
        pk = torch.einsum("bhsd,hdf->bhsf", k, w_phi)
        phi_q = torch.concatenate([_softmax(pq, axis=-1), _softmax(-pq, axis=-1)], axis=-1)
        phi_k = torch.concatenate([_softmax(pk, axis=-1), _softmax(-pk, axis=-1)], axis=-1)
        kv = torch.einsum("bhsf,bhsd->bhfd", phi_k, v)
        z  = torch.einsum("bhsf->bhf", phi_k)
        num = torch.einsum("bhqf,bhfd->bhqd", phi_q, kv)
        den = torch.einsum("bhqf,bhf->bhq", phi_q, z)[..., None] + 1e-6
        o = num / den
        return (lambda x, *d: x.permute(*d))(o, 0, 2, 1, 3).reshape(B, S, D) @ wo

    x = A_x
    g = _sigmoid((x * gate_w).sum(-1, keepdims=True))
    a = _A_ref(x, A_wqkv, A_wo)
    b = _B_ref(x, B_wqkv, B_w_phi, B_wo)
    return g * a + (1 - g) * b
```

```asm
; @launch grid=(256,1,1) block=(512,1,1) lds=163840
.amdgcn_target "amdgcn-amd-amdhsa--gfx950"
.text
.globl gated_mix__mha_block__linear_kernel_hedgehog__prompt_kernel
.p2align 8
.type gated_mix__mha_block__linear_kernel_hedgehog__prompt_kernel,@function
gated_mix__mha_block__linear_kernel_hedgehog__prompt_kernel:
    s_cmp_ge_u32 s2, 256
    s_cbranch_scc1 L_end
    s_load_dwordx2 s[28:29], s[0:1], 0
    s_load_dwordx2 s[32:33], s[0:1], 8
    s_load_dwordx2 s[36:37], s[0:1], 32
    s_getpc_b64 s[78:79]
L_pc:
    s_lshr_b32 s80, s2, 3
    s_lshl_b32 s80, s80, 7
    v_lshl_add_u32 v2, v0, 12, s80
    v_min_u32 v2, L_codeend-L_pc-4, v2
    v_cmp_gt_u32 vcc, 16, v0
    s_and_saveexec_b64 s[80:81], vcc
    s_cbranch_execz L_nopf
    global_load_dword v3, v2, s[78:79]
L_nopf:
    s_mov_b64 exec, -1
    v_lshrrev_b32 v2, 6, v0
    v_and_b32 v1, 63, v0
    v_readfirstlane_b32 s68, v2
    s_and_b32 s89, s2, 7
    s_lshr_b32 s78, s2, 3
    s_and_b32 s70, s78, 1
    s_bfe_u32 s79, s78, 0x10001
    s_and_b32 s69, s2, 6
    s_add_u32 s69, s69, s79
    s_and_b32 s79, s2, 1
    s_lshl_b32 s79, s79, 3
    s_lshr_b32 s71, s78, 2
    s_add_u32 s71, s71, s79
    s_and_b32 s79, s78, 3
    s_lshl_b32 s79, s79, 1
    s_add_u32 s18, s71, s79
    s_and_b32 s18, s18, 7
    v_lshrrev_b32 v2, 3, v1
    v_and_b32 v19, 7, v1
    v_bfe_u32 v18, v1, 4, 2
    v_xor_b32 v18, v18, v19
    v_lshlrev_b32 v18, 4, v18
    v_lshl_add_u32 v8, v2, 10, v18
    v_xor_b32 v9, 64, v8
    v_add_u32 v9, 7168, v9
    v_bfe_u32 v18, v1, 4, 1
    v_lshlrev_b32 v18, 2, v18
    v_xor_b32 v18, v18, v19
    v_lshlrev_b32 v18, 4, v18
    v_mul_u32_u24 v10, 3072, v2
    v_add_u32 v10, v10, v18
    s_lshl_b32 s79, s70, 10
    v_add_u32 v248, s79, v10
    v_add_u32 v249, s79, v248
    v_add_u32 v10, 1024, v248
    s_lshl_b32 s19, s71, 17
    s_lshl_b32 s79, s68, 14
    s_add_u32 s19, s19, s79
    s_mul_i32 s20, s68, 24576
    s_lshl_b32 s79, s69, 7
    s_add_u32 s20, s20, s79
    s_lshl_b32 s79, s18, 7
    s_add_u32 s84, s19, s79
    s_mul_i32 s79, s18, 196608
    s_add_u32 s85, s20, s79
    s_lshl_b32 s86, s68, 11
    s_lshl_b32 s87, s68, 10
    s_add_u32 s87, s87, 65536
    s_mov_b32 s30, 2097152
    s_mov_b32 s31, 0x20000
    s_mov_b32 s34, 1572864
    s_mov_b32 s35, 0x20000
    s_mov_b32 s38, 1572864
    s_mov_b32 s39, 0x20000
    s_mov_b32 s42, 1572864
    s_mov_b32 s43, 0x20000
    s_cmp_eq_u32 s70, 0
    s_waitcnt lgkmcnt(0)
    s_cselect_b32 s40, s32, s36
    s_cselect_b32 s41, s33, s37
    s_add_u32 m0, s86, 0
    s_nop 0
    buffer_load_dwordx4 v8, s[28:31], s84 offen lds
    buffer_load_dwordx4 v9, s[28:31], s84 offen offset:1024 lds
    s_add_u32 s18, s18, 1
    s_and_b32 s18, s18, 7
    s_lshl_b32 s84, s18, 7
    s_add_u32 s84, s84, s19
    s_add_u32 m0, s87, 32768
    s_nop 0
    buffer_load_dwordx4 v10, s[32:35], s85 offen lds
    s_add_u32 m0, s87, 40960
    s_nop 0
    buffer_load_dwordx4 v248, s[40:43], s85 offen lds
    s_mul_i32 s85, s18, 196608
    s_add_u32 s85, s85, s20
    s_load_dwordx2 s[44:45], s[0:1], 80
    s_load_dwordx2 s[48:49], s[0:1], 40
    s_load_dwordx2 s[56:57], s[0:1], 16
    s_load_dwordx2 s[60:61], s[0:1], 48
    s_load_dwordx2 s[64:65], s[0:1], 56
    s_load_dwordx2 s[52:53], s[0:1], 64
    s_waitcnt lgkmcnt(0)
    s_load_dwordx2 s[26:27], s[44:45], 0
    s_mov_b32 s50, 16384
    s_mov_b32 s51, 0x20000
    s_mov_b32 s66, 1024
    s_mov_b32 s67, 0x20000
    s_and_b32 s72, s68, 3
    s_lshr_b32 s73, s68, 2
    s_lshl_b32 s77, s69, 2
    s_lshl_b32 s79, s73, 1
    s_add_u32 s77, s77, s79
    v_lshlrev_b32 v17, 4, v1
    s_lshl_b32 s78, s77, 9
    buffer_load_dwordx4 v[4:7], v17, s[48:51], s78 offen
    s_lshl_b32 s17, s2, 3
    s_add_u32 s17, s17, s68
    s_lshl_b32 s78, s17, 10
    buffer_load_dwordx4 v[108:111], v17, s[28:31], s78 offen
    buffer_load_dwordx4 v[112:115], v17, s[64:67], 0 offen
    s_add_u32 m0, s86, 16384
    s_nop 0
    buffer_load_dwordx4 v8, s[28:31], s84 offen lds
    buffer_load_dwordx4 v9, s[28:31], s84 offen offset:1024 lds
    s_add_u32 s18, s18, 1
    s_and_b32 s18, s18, 7
    s_lshl_b32 s84, s18, 7
    s_add_u32 s84, s84, s19
    v_and_b32 v2, 31, v1
    v_lshrrev_b32 v244, 5, v1
    v_bfe_u32 v18, v1, 1, 3
    v_xor_b32 v18, v18, v244
    v_lshlrev_b32 v18, 4, v18
    s_lshl_b32 s78, s72, 12
    v_lshl_add_u32 v18, v2, 7, v18
    v_add_u32 v11, s78, v18
    v_xor_b32 v12, 32, v11
    v_xor_b32 v13, 64, v11
    v_xor_b32 v14, 96, v11
    v_bfe_u32 v18, v1, 2, 2
    v_lshl_add_u32 v18, v244, 3, v18
    v_lshlrev_b32 v18, 7, v18
    v_bfe_u32 v19, v1, 3, 1
    v_xor_b32 v19, s73, v19
    v_lshl_add_u32 v18, v19, 6, v18
    v_bfe_u32 v19, v1, 4, 1
    v_lshl_add_u32 v18, v19, 5, v18
    v_and_b32 v19, 3, v1
    v_lshl_add_u32 v18, v19, 3, v18
    v_add_u32 v15, 65536, v18
    v_add_u32 v16, 131072, v18
    s_cmp_eq_u32 s70, 0
    s_cbranch_scc0 L_type2
    s_mov_b32 s46, 23068672
    s_mov_b32 s47, 0x20000
    s_mov_b32 s54, 2097152
    s_mov_b32 s55, 0x20000
    s_lshr_b32 s78, s2, 3
    s_and_b32 s79, s78, 3
    s_lshl_b32 s74, s89, 2
    s_add_u32 s74, s74, s79
    s_lshr_b32 s75, s78, 2
    s_lshl_b32 s14, s89, 2
    s_and_b32 s79, s78, 1
    s_add_u32 s14, s14, s79
    s_lshl_b32 s14, s14, 1
    s_and_b32 s79, s68, 1
    s_add_u32 s14, s14, s79
    s_lshr_b32 s15, s78, 1
    s_lshl_b32 s15, s15, 6
    s_mov_b32 s16, s72
    s_lshl_b32 s76, s71, 2
    s_add_u32 s76, s76, s72
    s_lshl_b32 s23, s77, 16
    s_lshl_b32 s80, s76, 10
    s_add_u32 s23, s23, s80
    s_lshl_b32 s22, s69, 2
    s_add_u32 s22, s22, s73
    s_lshl_b32 s22, s22, 6
    s_add_u32 s22, s22, s76
    s_lshl_b32 s22, s22, 3
    s_lshl_b32 s80, s70, 10
    s_add_u32 s22, s22, s80
    s_add_u32 s22, s22, 4096
    v_mov_b32 v252, 0
    s_mov_b32 s10, 0x3fb8aa3b
    s_mov_b32 s11, 0x3fb8aa3b
    s_mov_b32 s12, 0x3eb8aa3b
    s_mov_b32 s13, 0x3eb8aa3b
    s_mov_b32 s4, 0xffff
    s_mov_b32 s5, 0xffff
    s_bfe_u32 s79, s74, 0x10001
    s_lshl_b32 s80, s89, 2
    s_add_u32 s80, s80, s79
    s_lshl_b32 s80, s80, 9
    s_add_u32 s80, s80, 4096
    s_lshl_b32 s81, s68, 6
    s_add_u32 s81, s81, s80
    s_lshl_b32 s78, s75, 6
    s_add_u32 s78, s78, s80
    v_and_b32 v18, 7, v1
    v_lshlrev_b32 v18, 3, v18
    v_bfe_u32 v19, v1, 3, 1
    v_lshl_add_u32 v19, v19, 10, v18
    v_add_u32 v19, s81, v19
    v_add_u32 v18, s78, v18
    v_cmp_gt_u32 s[78:79], 16, v1
    s_nop 1
    v_cndmask_b32 v253, v18, v19, s[78:79]
    v_and_b32 v19, 15, v1
    v_lshlrev_b32 v19, 4, v19
    v_lshl_add_u32 v255, v244, 8, v19
    s_lshl_b32 s78, s68, 10
    s_add_u32 s78, s78, 16384
    v_bfe_u32 v18, v1, 2, 2
    v_lshl_add_u32 v18, v244, 2, v18
    v_lshlrev_b32 v18, 5, v18
    v_and_b32 v19, 3, v1
    v_lshl_add_u32 v18, v19, 3, v18
    v_add_u32 v18, s78, v18
    v_bfe_u32 v19, v1, 4, 1
    v_mul_u32_u24 v19, 0x8000, v19
    v_lshl_or_b32 v19, v19, 16, v19
    v_add_u32 v247, s78, v17
    v_bfe_u32 v44, v1, 2, 2
    v_lshl_add_u32 v44, v244, 2, v44
    v_lshlrev_b32 v44, 6, v44
    v_bfe_u32 v45, v1, 4, 1
    v_lshl_add_u32 v44, v45, 5, v44
    v_and_b32 v45, 3, v1
    v_lshl_add_u32 v44, v45, 3, v44
    v_add_u32 v0, 98304, v44
    v_mul_u32_u24 v44, 144, v2
    v_lshl_add_u32 v246, v244, 4, v44
    s_getpc_b64 s[8:9]
L_pcs0:
    s_add_u32 s8, s8, L_slow-L_pcs0
    s_addc_u32 s9, s9, 0
    s_waitcnt lgkmcnt(0)
    s_add_u32 s26, s26, 0x9e3779b9
    s_addc_u32 s27, s27, 0x7f4a7c15
    v_mov_b32 v250, s26
    v_mov_b32 v251, s27
    s_waitcnt vmcnt(5) lgkmcnt(0)
    s_barrier
    ds_read_b128 v[116:119], v11 offset:0
    ds_read_b64_tr_b16 v[20:21], v15 offset:32768
    ds_read_b64_tr_b16 v[22:23], v15 offset:33280
    ds_read_b64_tr_b16 v[24:25], v15 offset:40960
    ds_read_b64_tr_b16 v[26:27], v15 offset:41472
    ds_read_b128 v[120:123], v12 offset:0
    ds_read_b64_tr_b16 v[28:29], v15 offset:34816
    ds_read_b64_tr_b16 v[30:31], v15 offset:35328
    ds_read_b64_tr_b16 v[32:33], v15 offset:43008
    ds_read_b64_tr_b16 v[34:35], v15 offset:43520
    ds_read_b128 v[124:127], v13 offset:0
    ds_read_b64_tr_b16 v[36:37], v15 offset:36864
    ds_read_b64_tr_b16 v[38:39], v15 offset:37376
    s_waitcnt lgkmcnt(10)
    v_mfma_f32_32x32x16_bf16 v[52:67], v[20:23], v[116:119], 0
    s_add_u32 m0, s87, 49152
    ds_read_b64_tr_b16 v[40:41], v15 offset:45056
    ds_read_b64_tr_b16 v[42:43], v15 offset:45568
    buffer_load_dwordx4 v10, s[32:35], s85 offen lds
    s_waitcnt lgkmcnt(10)
    v_mfma_f32_32x32x16_bf16 v[68:83], v[24:27], v[116:119], 0
    s_add_u32 m0, s87, 57344
    ds_read_b128 v[128:131], v14 offset:0
    ds_read_b64_tr_b16 v[20:21], v15 offset:38912
    ds_read_b64_tr_b16 v[22:23], v15 offset:39424
    buffer_load_dwordx4 v248, s[40:43], s85 offen lds
    s_mul_i32 s85, s18, 196608
    s_add_u32 s85, s85, s20
    s_waitcnt lgkmcnt(10)
    v_mfma_f32_32x32x16_bf16 v[52:67], v[28:31], v[120:123], v[52:67]
    s_add_u32 m0, s86, 32768
    ds_read_b64_tr_b16 v[24:25], v15 offset:47104
    ds_read_b64_tr_b16 v[26:27], v15 offset:47616
    buffer_load_dwordx4 v8, s[28:31], s84 offen lds
    s_waitcnt lgkmcnt(10)
    v_mfma_f32_32x32x16_bf16 v[68:83], v[32:35], v[120:123], v[68:83]
    s_waitcnt vmcnt(1)
    s_barrier
    ds_read_b128 v[132:135], v11 offset:16384
    ds_read_b64_tr_b16 v[28:29], v15 offset:49152
    ds_read_b64_tr_b16 v[30:31], v15 offset:49664
    buffer_load_dwordx4 v9, s[28:31], s84 offen offset:1024 lds
    s_add_u32 s18, s18, 1
    s_and_b32 s18, s18, 7
    s_lshl_b32 s84, s18, 7
    s_add_u32 s84, s84, s19
    s_waitcnt lgkmcnt(10)
    v_mfma_f32_32x32x16_bf16 v[52:67], v[36:39], v[124:127], v[52:67]
    s_add_u32 m0, s87, 65536
    ds_read_b64_tr_b16 v[32:33], v15 offset:57344
    ds_read_b64_tr_b16 v[34:35], v15 offset:57856
    buffer_load_dwordx4 v10, s[32:35], s85 offen lds
    s_waitcnt lgkmcnt(10)
    v_mfma_f32_32x32x16_bf16 v[68:83], v[40:43], v[124:127], v[68:83]
    s_add_u32 m0, s87, 73728
    ds_read_b128 v[136:139], v12 offset:16384
    ds_read_b64_tr_b16 v[36:37], v15 offset:51200
    ds_read_b64_tr_b16 v[38:39], v15 offset:51712
    buffer_load_dwordx4 v248, s[40:43], s85 offen lds
    s_mul_i32 s85, s18, 196608
    s_add_u32 s85, s85, s20
    s_waitcnt lgkmcnt(10)
    v_mfma_f32_32x32x16_bf16 v[52:67], v[20:23], v[128:131], v[52:67]
    s_add_u32 m0, s86, 49152
    ds_read_b64_tr_b16 v[40:41], v15 offset:59392
    ds_read_b64_tr_b16 v[42:43], v15 offset:59904
    buffer_load_dwordx4 v8, s[28:31], s84 offen lds
    s_waitcnt lgkmcnt(10)
    v_mfma_f32_32x32x16_bf16 v[68:83], v[24:27], v[128:131], v[68:83]
    ds_read_b128 v[140:143], v13 offset:16384
    ds_read_b64_tr_b16 v[20:21], v15 offset:53248
    ds_read_b64_tr_b16 v[22:23], v15 offset:53760
    v_dot2_f32_bf16 v46, v108, v112, 0
    v_dot2_f32_bf16 v47, v109, v113, 0
    s_waitcnt lgkmcnt(10)
    v_mfma_f32_32x32x16_bf16 v[52:67], v[28:31], v[132:135], v[52:67]
    ds_read_b64_tr_b16 v[24:25], v15 offset:61440
    ds_read_b64_tr_b16 v[26:27], v15 offset:61952
    buffer_load_dwordx4 v9, s[28:31], s84 offen offset:1024 lds
    s_add_u32 s18, s18, 1
    s_and_b32 s18, s18, 7
    s_lshl_b32 s84, s18, 7
    s_add_u32 s84, s84, s19
    s_waitcnt lgkmcnt(10)
    v_mfma_f32_32x32x16_bf16 v[68:83], v[32:35], v[132:135], v[68:83]
    ds_read_b128 v[144:147], v14 offset:16384
    ds_read_b64_tr_b16 v[28:29], v15 offset:55296
    ds_read_b64_tr_b16 v[30:31], v15 offset:55808
    v_dot2_f32_bf16 v46, v110, v114, v46
    v_dot2_f32_bf16 v47, v111, v115, v47
    s_waitcnt lgkmcnt(10)
    v_mfma_f32_32x32x16_bf16 v[52:67], v[36:39], v[136:139], v[52:67]
    s_add_u32 m0, s87, 81920
    ds_read_b64_tr_b16 v[32:33], v15 offset:63488
    ds_read_b64_tr_b16 v[34:35], v15 offset:64000
    buffer_load_dwordx4 v10, s[32:35], s85 offen lds
    s_waitcnt lgkmcnt(10)
    v_mfma_f32_32x32x16_bf16 v[68:83], v[40:43], v[136:139], v[68:83]
    s_waitcnt vmcnt(3)
    s_barrier
    s_add_u32 m0, s87, 90112
    ds_read_b128 v[148:151], v11 offset:32768
    ds_read_b64_tr_b16 v[36:37], v16 offset:0
    ds_read_b64_tr_b16 v[38:39], v16 offset:512
    buffer_load_dwordx4 v248, s[40:43], s85 offen lds
    s_mul_i32 s85, s18, 196608
    s_add_u32 s85, s85, s20
    s_waitcnt lgkmcnt(10)
    v_mfma_f32_32x32x16_bf16 v[52:67], v[20:23], v[140:143], v[52:67]
    s_add_u32 m0, s86, 0
    ds_read_b64_tr_b16 v[40:41], v16 offset:8192
    ds_read_b64_tr_b16 v[42:43], v16 offset:8704
    buffer_load_dwordx4 v8, s[28:31], s84 offen lds
    s_waitcnt lgkmcnt(10)
    v_mfma_f32_32x32x16_bf16 v[68:83], v[24:27], v[140:143], v[68:83]
    ds_read_b128 v[152:155], v12 offset:32768
    ds_read_b64_tr_b16 v[20:21], v16 offset:2048
    ds_read_b64_tr_b16 v[22:23], v16 offset:2560
    s_lshl_b32 s17, s17, 2
    s_add_u32 s17, s17, 131072
    s_waitcnt lgkmcnt(10)
    v_mfma_f32_32x32x16_bf16 v[52:67], v[28:31], v[144:147], v[52:67]
    ds_read_b64_tr_b16 v[24:25], v16 offset:10240
    ds_read_b64_tr_b16 v[26:27], v16 offset:10752
    buffer_load_dwordx4 v9, s[28:31], s84 offen offset:1024 lds
    s_add_u32 s18, s18, 1
    s_and_b32 s18, s18, 7
    s_lshl_b32 s84, s18, 7
    s_add_u32 s84, s84, s19
    s_waitcnt lgkmcnt(10)
    v_mfma_f32_32x32x16_bf16 v[68:83], v[32:35], v[144:147], v[68:83]
    ds_read_b128 v[156:159], v13 offset:32768
    ds_read_b64_tr_b16 v[28:29], v16 offset:4096
    ds_read_b64_tr_b16 v[30:31], v16 offset:4608
    v_add_f32 v46, v46, v47
    s_waitcnt lgkmcnt(10)
    v_mfma_f32_32x32x16_bf16 v[52:67], v[36:39], v[148:151], v[52:67]
    s_add_u32 m0, s87, 0
    ds_read_b64_tr_b16 v[32:33], v16 offset:12288
    ds_read_b64_tr_b16 v[34:35], v16 offset:12800
    buffer_load_dwordx4 v10, s[32:35], s85 offen lds
    s_waitcnt lgkmcnt(10)
    v_mfma_f32_32x32x16_bf16 v[68:83], v[40:43], v[148:151], v[68:83]
    ds_read_b128 v[160:163], v14 offset:32768
    ds_read_b64_tr_b16 v[36:37], v16 offset:6144
    ds_read_b64_tr_b16 v[38:39], v16 offset:6656
    v_add_f32_dpp v46, v46, v46 quad_perm:[1,0,3,2] row_mask:0xf bank_mask:0xf
    s_waitcnt lgkmcnt(10)
    v_mfma_f32_32x32x16_bf16 v[52:67], v[20:23], v[152:155], v[52:67]
    s_add_u32 m0, s87, 8192
    ds_read_b64_tr_b16 v[40:41], v16 offset:14336
    ds_read_b64_tr_b16 v[42:43], v16 offset:14848
    buffer_load_dwordx4 v248, s[40:43], s85 offen lds
    s_mul_i32 s85, s18, 196608
    s_add_u32 s85, s85, s20
    s_waitcnt lgkmcnt(10)
    v_mfma_f32_32x32x16_bf16 v[68:83], v[24:27], v[152:155], v[68:83]
    s_waitcnt vmcnt(4)
    s_barrier
    ds_read_b128 v[164:167], v11 offset:49152
    ds_read_b64_tr_b16 v[20:21], v16 offset:16384
    ds_read_b64_tr_b16 v[22:23], v16 offset:16896
    v_add_f32_dpp v46, v46, v46 quad_perm:[2,3,0,1] row_mask:0xf bank_mask:0xf
    s_waitcnt lgkmcnt(10)
    v_mfma_f32_32x32x16_bf16 v[52:67], v[28:31], v[156:159], v[52:67]
    s_add_u32 m0, s86, 16384
    ds_read_b64_tr_b16 v[24:25], v16 offset:24576
    ds_read_b64_tr_b16 v[26:27], v16 offset:25088
    buffer_load_dwordx4 v8, s[28:31], s84 offen lds
    s_waitcnt lgkmcnt(10)
    v_mfma_f32_32x32x16_bf16 v[68:83], v[32:35], v[156:159], v[68:83]
    ds_read_b128 v[168:171], v12 offset:49152
    ds_read_b64_tr_b16 v[28:29], v16 offset:18432
    ds_read_b64_tr_b16 v[30:31], v16 offset:18944
    v_add_f32_dpp v46, v46, v46 row_half_mirror row_mask:0xf bank_mask:0xf
    s_waitcnt lgkmcnt(10)
    v_mfma_f32_32x32x16_bf16 v[52:67], v[36:39], v[160:163], v[52:67]
    ds_read_b64_tr_b16 v[32:33], v16 offset:26624
    ds_read_b64_tr_b16 v[34:35], v16 offset:27136
    buffer_load_dwordx4 v9, s[28:31], s84 offen offset:1024 lds
    s_add_u32 s18, s18, 1
    s_and_b32 s18, s18, 7
    s_lshl_b32 s84, s18, 7
    s_add_u32 s84, s84, s19
    s_waitcnt lgkmcnt(10)
    v_mfma_f32_32x32x16_bf16 v[68:83], v[40:43], v[160:163], v[68:83]
    ds_read_b128 v[172:175], v13 offset:49152
    ds_read_b64_tr_b16 v[36:37], v16 offset:20480
    ds_read_b64_tr_b16 v[38:39], v16 offset:20992
    v_add_f32_dpp v46, v46, v46 row_mirror row_mask:0xf bank_mask:0xf
    s_waitcnt lgkmcnt(10)
    v_mfma_f32_32x32x16_bf16 v[52:67], v[20:23], v[164:167], v[52:67]
    s_add_u32 m0, s87, 16384
    ds_read_b64_tr_b16 v[40:41], v16 offset:28672
    ds_read_b64_tr_b16 v[42:43], v16 offset:29184
    buffer_load_dwordx4 v10, s[32:35], s85 offen lds
    s_waitcnt lgkmcnt(10)
    v_mfma_f32_32x32x16_bf16 v[68:83], v[24:27], v[164:167], v[68:83]
    ds_read_b128 v[176:179], v14 offset:49152
    ds_read_b64_tr_b16 v[20:21], v16 offset:22528
    ds_read_b64_tr_b16 v[22:23], v16 offset:23040
    v_mov_b32 v47, v46
    s_waitcnt lgkmcnt(10)
    v_mfma_f32_32x32x16_bf16 v[52:67], v[28:31], v[168:171], v[52:67]
    s_add_u32 m0, s87, 24576
    ds_read_b64_tr_b16 v[24:25], v16 offset:30720
    ds_read_b64_tr_b16 v[26:27], v16 offset:31232
    buffer_load_dwordx4 v248, s[40:43], s85 offen lds
    s_mul_i32 s85, s18, 196608
    s_add_u32 s85, s85, s20
    s_waitcnt lgkmcnt(10)
    v_mfma_f32_32x32x16_bf16 v[68:83], v[32:35], v[168:171], v[68:83]
    s_waitcnt vmcnt(4)
    s_barrier
    ds_read_b128 v[180:183], v11 offset:0
    ds_read_b64_tr_b16 v[28:29], v15 offset:0
    ds_read_b64_tr_b16 v[30:31], v15 offset:512
    v_permlane16_swap_b32 v46, v47
    s_waitcnt lgkmcnt(10)
    v_mfma_f32_32x32x16_bf16 v[52:67], v[36:39], v[172:175], v[52:67]
    s_add_u32 m0, s86, 32768
    ds_read_b64_tr_b16 v[32:33], v15 offset:8192
    ds_read_b64_tr_b16 v[34:35], v15 offset:8704
    buffer_load_dwordx4 v8, s[28:31], s84 offen lds
    s_waitcnt lgkmcnt(10)
    v_mfma_f32_32x32x16_bf16 v[68:83], v[40:43], v[172:175], v[68:83]
    ds_read_b128 v[184:187], v12 offset:0
    ds_read_b64_tr_b16 v[36:37], v15 offset:2048
    ds_read_b64_tr_b16 v[38:39], v15 offset:2560
    v_add_f32 v46, v46, v47
    v_mov_b32 v47, v46
    s_waitcnt lgkmcnt(10)
    v_mfma_f32_32x32x16_bf16 v[52:67], v[20:23], v[176:179], v[52:67]
    ds_read_b64_tr_b16 v[40:41], v15 offset:10240
    ds_read_b64_tr_b16 v[42:43], v15 offset:10752
    buffer_load_dwordx4 v9, s[28:31], s84 offen offset:1024 lds
    s_add_u32 s18, s18, 1
    s_and_b32 s18, s18, 7
    s_lshl_b32 s84, s18, 7
    s_add_u32 s84, s84, s19
    s_waitcnt lgkmcnt(10)
    v_mfma_f32_32x32x16_bf16 v[68:83], v[24:27], v[176:179], v[68:83]
    ds_read_b128 v[188:191], v13 offset:0
    ds_read_b64_tr_b16 v[20:21], v15 offset:4096
    ds_read_b64_tr_b16 v[22:23], v15 offset:4608
    v_permlane32_swap_b32 v46, v47
    s_waitcnt lgkmcnt(10)
    v_mfma_f32_32x32x16_bf16 v[52:67], v[28:31], v[180:183], v[52:67]
    s_add_u32 m0, s87, 32768
    ds_read_b64_tr_b16 v[24:25], v15 offset:12288
    ds_read_b64_tr_b16 v[26:27], v15 offset:12800
    buffer_load_dwordx4 v10, s[32:35], s85 offen lds
    s_waitcnt lgkmcnt(10)
    v_mfma_f32_32x32x16_bf16 v[68:83], v[32:35], v[180:183], v[68:83]
    ds_read_b128 v[192:195], v14 offset:0
    ds_read_b64_tr_b16 v[28:29], v15 offset:6144
    ds_read_b64_tr_b16 v[30:31], v15 offset:6656
    v_add_f32 v46, v46, v47
    v_mul_f32 v46, s10, v46
    s_waitcnt lgkmcnt(10)
    v_mfma_f32_32x32x16_bf16 v[52:67], v[36:39], v[184:187], v[52:67]
    s_add_u32 m0, s87, 40960
    ds_read_b64_tr_b16 v[32:33], v15 offset:14336
    ds_read_b64_tr_b16 v[34:35], v15 offset:14848
    buffer_load_dwordx4 v248, s[40:43], s85 offen lds
    s_mul_i32 s85, s18, 196608
    s_add_u32 s85, s85, s20
    s_waitcnt lgkmcnt(10)
    v_mfma_f32_32x32x16_bf16 v[68:83], v[40:43], v[184:187], v[68:83]
    s_waitcnt vmcnt(4)
    s_barrier
    ds_read_b128 v[196:199], v11 offset:16384
    ds_read_b64_tr_b16 v[36:37], v15 offset:16384
    ds_read_b64_tr_b16 v[38:39], v15 offset:16896
    v_exp_f32 v46, -v46
    s_waitcnt lgkmcnt(10)
    v_mfma_f32_32x32x16_bf16 v[52:67], v[20:23], v[188:191], v[52:67]
    s_add_u32 m0, s86, 49152
    ds_read_b64_tr_b16 v[40:41], v15 offset:24576
    ds_read_b64_tr_b16 v[42:43], v15 offset:25088
    buffer_load_dwordx4 v8, s[28:31], s84 offen lds
    s_waitcnt lgkmcnt(10)
    v_mfma_f32_32x32x16_bf16 v[68:83], v[24:27], v[188:191], v[68:83]
    ds_read_b128 v[200:203], v12 offset:16384
    ds_read_b64_tr_b16 v[20:21], v15 offset:18432
    ds_read_b64_tr_b16 v[22:23], v15 offset:18944
    v_add_f32 v46, 1.0, v46
    s_waitcnt lgkmcnt(10)
    v_mfma_f32_32x32x16_bf16 v[52:67], v[28:31], v[192:195], v[52:67]
    ds_read_b64_tr_b16 v[24:25], v15 offset:26624
    ds_read_b64_tr_b16 v[26:27], v15 offset:27136
    buffer_load_dwordx4 v9, s[28:31], s84 offen offset:1024 lds
    s_add_u32 s18, s18, 1
    s_and_b32 s18, s18, 7
    s_lshl_b32 s84, s18, 7
    s_add_u32 s84, s84, s19
    s_waitcnt lgkmcnt(10)
    v_mfma_f32_32x32x16_bf16 v[68:83], v[32:35], v[192:195], v[68:83]
    ds_read_b128 v[204:207], v13 offset:16384
    ds_read_b64_tr_b16 v[28:29], v15 offset:20480
    ds_read_b64_tr_b16 v[30:31], v15 offset:20992
    v_rcp_f32 v46, v46
    s_waitcnt lgkmcnt(10)
    v_mfma_f32_32x32x16_bf16 v[52:67], v[36:39], v[196:199], v[52:67]
    s_add_u32 m0, s87, 49152
    ds_read_b64_tr_b16 v[32:33], v15 offset:28672
    ds_read_b64_tr_b16 v[34:35], v15 offset:29184
    buffer_load_dwordx4 v10, s[32:35], s85 offen lds
    s_waitcnt lgkmcnt(10)
    v_mfma_f32_32x32x16_bf16 v[68:83], v[40:43], v[196:199], v[68:83]
    ds_read_b128 v[208:211], v14 offset:16384
    ds_read_b64_tr_b16 v[36:37], v15 offset:22528
    ds_read_b64_tr_b16 v[38:39], v15 offset:23040
    s_waitcnt lgkmcnt(10)
    v_mfma_f32_32x32x16_bf16 v[52:67], v[20:23], v[200:203], v[52:67]
    s_add_u32 m0, s87, 57344
    ds_read_b64_tr_b16 v[40:41], v15 offset:30720
    ds_read_b64_tr_b16 v[42:43], v15 offset:31232
    buffer_load_dwordx4 v248, s[40:43], s85 offen lds
    s_mul_i32 s85, s18, 196608
    s_add_u32 s85, s85, s20
    s_waitcnt lgkmcnt(10)
    v_mfma_f32_32x32x16_bf16 v[68:83], v[24:27], v[200:203], v[68:83]
    s_waitcnt vmcnt(4)
    s_barrier
    ds_read_b128 v[212:215], v11 offset:32768
    ds_read_b64_tr_b16 v[20:21], v15 offset:32768
    ds_read_b64_tr_b16 v[22:23], v15 offset:33280
    s_waitcnt lgkmcnt(10)
    v_mfma_f32_32x32x16_bf16 v[52:67], v[28:31], v[204:207], v[52:67]
    s_add_u32 m0, s87, 65536
    ds_read_b64_tr_b16 v[24:25], v15 offset:40960
    ds_read_b64_tr_b16 v[26:27], v15 offset:41472
    buffer_load_dwordx4 v249, s[36:39], s85 offen lds
    s_add_u32 s18, s18, 1
    s_and_b32 s18, s18, 7
    s_mul_i32 s85, s18, 196608
    s_add_u32 s85, s85, s20
    s_waitcnt lgkmcnt(10)
    v_mfma_f32_32x32x16_bf16 v[68:83], v[32:35], v[204:207], v[68:83]
    ds_read_b128 v[216:219], v12 offset:32768
    ds_read_b64_tr_b16 v[28:29], v15 offset:34816
    ds_read_b64_tr_b16 v[30:31], v15 offset:35328
    s_waitcnt lgkmcnt(10)
    v_mfma_f32_32x32x16_bf16 v[52:67], v[36:39], v[208:211], v[52:67]
    s_add_u32 m0, s87, 73728
    ds_read_b64_tr_b16 v[32:33], v15 offset:43008
    ds_read_b64_tr_b16 v[34:35], v15 offset:43520
    buffer_load_dwordx4 v249, s[36:39], s85 offen lds
    s_add_u32 s18, s18, 1
    s_and_b32 s18, s18, 7
    s_mul_i32 s85, s18, 196608
    s_add_u32 s85, s85, s20
    s_waitcnt lgkmcnt(10)
    v_mfma_f32_32x32x16_bf16 v[68:83], v[40:43], v[208:211], v[68:83]
    ds_read_b128 v[220:223], v13 offset:32768
    ds_read_b64_tr_b16 v[36:37], v15 offset:36864
    ds_read_b64_tr_b16 v[38:39], v15 offset:37376
    s_waitcnt lgkmcnt(10)
    v_mfma_f32_32x32x16_bf16 v[52:67], v[20:23], v[212:215], v[52:67]
    s_add_u32 m0, s87, 81920
    ds_read_b64_tr_b16 v[40:41], v15 offset:45056
    ds_read_b64_tr_b16 v[42:43], v15 offset:45568
    buffer_load_dwordx4 v249, s[36:39], s85 offen lds
    s_add_u32 s18, s18, 1
    s_and_b32 s18, s18, 7
    s_mul_i32 s85, s18, 196608
    s_add_u32 s85, s85, s20
    s_waitcnt lgkmcnt(10)
    v_mfma_f32_32x32x16_bf16 v[68:83], v[24:27], v[212:215], v[68:83]
    s_add_u32 m0, s87, 90112
    ds_read_b128 v[224:227], v14 offset:32768
    ds_read_b64_tr_b16 v[20:21], v15 offset:38912
    ds_read_b64_tr_b16 v[22:23], v15 offset:39424
    buffer_load_dwordx4 v249, s[36:39], s85 offen lds
    s_add_u32 s18, s18, 1
    s_and_b32 s18, s18, 7
    s_mul_i32 s85, s18, 196608
    s_add_u32 s85, s85, s20
    s_waitcnt lgkmcnt(10)
    v_mfma_f32_32x32x16_bf16 v[52:67], v[28:31], v[216:219], v[52:67]
    s_add_u32 m0, s87, 0
    ds_read_b64_tr_b16 v[24:25], v15 offset:47104
    ds_read_b64_tr_b16 v[26:27], v15 offset:47616
    buffer_load_dwordx4 v249, s[36:39], s85 offen lds
    s_add_u32 s18, s18, 1
    s_and_b32 s18, s18, 7
    s_mul_i32 s85, s18, 196608
    s_add_u32 s85, s85, s20
    s_waitcnt lgkmcnt(10)
    v_mfma_f32_32x32x16_bf16 v[68:83], v[32:35], v[216:219], v[68:83]
    s_waitcnt vmcnt(5)
    s_barrier
    s_add_u32 m0, s87, 8192
    ds_read_b128 v[228:231], v11 offset:49152
    ds_read_b64_tr_b16 v[28:29], v15 offset:49152
    ds_read_b64_tr_b16 v[30:31], v15 offset:49664
    buffer_load_dwordx4 v249, s[36:39], s85 offen lds
    s_add_u32 s18, s18, 1
    s_and_b32 s18, s18, 7
    s_mul_i32 s85, s18, 196608
    s_add_u32 s85, s85, s20
    s_waitcnt lgkmcnt(10)
    v_mfma_f32_32x32x16_bf16 v[52:67], v[36:39], v[220:223], v[52:67]
    s_add_u32 m0, s87, 16384
    ds_read_b64_tr_b16 v[32:33], v15 offset:57344
    ds_read_b64_tr_b16 v[34:35], v15 offset:57856
    buffer_load_dwordx4 v249, s[36:39], s85 offen lds
    s_add_u32 s18, s18, 1
    s_and_b32 s18, s18, 7
    s_mul_i32 s85, s18, 196608
    s_add_u32 s85, s85, s20
    s_waitcnt lgkmcnt(10)
    v_mfma_f32_32x32x16_bf16 v[68:83], v[40:43], v[220:223], v[68:83]
    s_add_u32 m0, s87, 24576
    ds_read_b128 v[232:235], v12 offset:49152
    ds_read_b64_tr_b16 v[36:37], v15 offset:51200
    ds_read_b64_tr_b16 v[38:39], v15 offset:51712
    buffer_load_dwordx4 v249, s[36:39], s85 offen lds
    s_add_u32 s18, s18, 1
    s_and_b32 s18, s18, 7
    s_mul_i32 s85, s18, 196608
    s_add_u32 s85, s85, s20
    s_waitcnt lgkmcnt(10)
    v_mfma_f32_32x32x16_bf16 v[52:67], v[20:23], v[224:227], v[52:67]
    ds_read_b64_tr_b16 v[40:41], v15 offset:59392
    ds_read_b64_tr_b16 v[42:43], v15 offset:59904
    s_waitcnt lgkmcnt(10)
    v_mfma_f32_32x32x16_bf16 v[68:83], v[24:27], v[224:227], v[68:83]
    ds_read_b128 v[236:239], v13 offset:49152
    ds_read_b64_tr_b16 v[20:21], v15 offset:53248
    ds_read_b64_tr_b16 v[22:23], v15 offset:53760
    s_waitcnt lgkmcnt(10)
    v_mfma_f32_32x32x16_bf16 v[52:67], v[28:31], v[228:231], v[52:67]
    ds_read_b64_tr_b16 v[24:25], v15 offset:61440
    ds_read_b64_tr_b16 v[26:27], v15 offset:61952
    s_waitcnt lgkmcnt(10)
    v_mfma_f32_32x32x16_bf16 v[68:83], v[32:35], v[228:231], v[68:83]
    ds_read_b128 v[240:243], v14 offset:49152
    ds_read_b64_tr_b16 v[28:29], v15 offset:55296
    ds_read_b64_tr_b16 v[30:31], v15 offset:55808
    s_waitcnt lgkmcnt(10)
    v_mfma_f32_32x32x16_bf16 v[52:67], v[36:39], v[232:235], v[52:67]
    ds_read_b64_tr_b16 v[32:33], v15 offset:63488
    ds_read_b64_tr_b16 v[34:35], v15 offset:64000
    s_waitcnt lgkmcnt(10)
    v_mfma_f32_32x32x16_bf16 v[68:83], v[40:43], v[232:235], v[68:83]
    s_waitcnt vmcnt(6)
    s_barrier
    ds_read_b64_tr_b16 v[36:37], v16 offset:0
    ds_read_b64_tr_b16 v[38:39], v16 offset:512
    s_waitcnt lgkmcnt(9)
    v_mfma_f32_32x32x16_bf16 v[52:67], v[20:23], v[236:239], v[52:67]
    ds_read_b64_tr_b16 v[40:41], v16 offset:2048
    ds_read_b64_tr_b16 v[42:43], v16 offset:2560
    s_waitcnt lgkmcnt(9)
    v_mfma_f32_32x32x16_bf16 v[68:83], v[24:27], v[236:239], v[68:83]
    ds_read_b64_tr_b16 v[20:21], v16 offset:4096
    ds_read_b64_tr_b16 v[22:23], v16 offset:4608
    s_waitcnt lgkmcnt(8)
    v_mfma_f32_32x32x16_bf16 v[52:67], v[28:31], v[240:243], v[52:67]
    ds_read_b64_tr_b16 v[24:25], v16 offset:6144
    ds_read_b64_tr_b16 v[26:27], v16 offset:6656
    s_cmp_ge_u32 s16, 2
    s_cselect_b32 s40, s56, s60
    s_cselect_b32 s41, s57, s61
    s_mov_b32 s42, 524288
    s_waitcnt lgkmcnt(8)
    v_mfma_f32_32x32x16_bf16 v[68:83], v[32:35], v[240:243], v[68:83]
    ds_read_b64_tr_b16 v[28:29], v16 offset:8192
    ds_read_b64_tr_b16 v[30:31], v16 offset:8704
    s_waitcnt lgkmcnt(8)
    v_mfma_f32_32x32x16_bf16 v[84:99], v[36:39], v[116:119], 0
    ds_read_b64_tr_b16 v[32:33], v16 offset:10240
    ds_read_b64_tr_b16 v[34:35], v16 offset:10752
    s_waitcnt lgkmcnt(8)
    v_mfma_f32_32x32x16_bf16 v[84:99], v[40:43], v[120:123], v[84:99]
    ds_read_b64_tr_b16 v[36:37], v16 offset:12288
    ds_read_b64_tr_b16 v[38:39], v16 offset:12800
    v_cvt_pk_bf16_f32 v52, v52, v53
    v_cvt_pk_bf16_f32 v53, v54, v55
    v_cvt_pk_bf16_f32 v54, v56, v57
    v_cvt_pk_bf16_f32 v55, v58, v59
    s_waitcnt lgkmcnt(8)
    v_mfma_f32_32x32x16_bf16 v[84:99], v[20:23], v[124:127], v[84:99]
    ds_read_b64_tr_b16 v[40:41], v16 offset:14336
    ds_read_b64_tr_b16 v[42:43], v16 offset:14848
    v_cvt_pk_bf16_f32 v56, v60, v61
    v_cvt_pk_bf16_f32 v57, v62, v63
    v_cvt_pk_bf16_f32 v58, v64, v65
    v_cvt_pk_bf16_f32 v59, v66, v67
    s_waitcnt lgkmcnt(8)
    v_mfma_f32_32x32x16_bf16 v[84:99], v[24:27], v[128:131], v[84:99]
    s_waitcnt vmcnt(4)
    s_barrier
    ds_read_b64_tr_b16 v[20:21], v16 offset:16384
    ds_read_b64_tr_b16 v[22:23], v16 offset:16896
    s_add_u32 s80, s23, 3145728
    s_add_u32 s81, s23, 3211264
    buffer_store_dwordx4 v[52:55], v17, s[44:47], s80 offen sc1
    s_waitcnt lgkmcnt(8)
    v_mfma_f32_32x32x16_bf16 v[84:99], v[28:31], v[132:135], v[84:99]
    ds_read_b64_tr_b16 v[24:25], v16 offset:18432
    ds_read_b64_tr_b16 v[26:27], v16 offset:18944
    buffer_store_dwordx4 v[56:59], v17, s[44:47], s81 offen sc1
    s_waitcnt lgkmcnt(8)
    v_mfma_f32_32x32x16_bf16 v[84:99], v[32:35], v[136:139], v[84:99]
    ds_read_b64_tr_b16 v[28:29], v16 offset:20480
    ds_read_b64_tr_b16 v[30:31], v16 offset:20992
    v_mul_f32 v68, s12, v68
    v_mul_f32 v69, s13, v69
    v_mul_f32 v70, s12, v70
    v_mul_f32 v71, s13, v71
    v_mul_f32 v72, s12, v72
    v_mul_f32 v73, s13, v73
    v_mul_f32 v74, s12, v74
    v_mul_f32 v75, s13, v75
    s_waitcnt lgkmcnt(8)
    v_mfma_f32_32x32x16_bf16 v[84:99], v[36:39], v[140:143], v[84:99]
    ds_read_b64_tr_b16 v[32:33], v16 offset:22528
    ds_read_b64_tr_b16 v[34:35], v16 offset:23040
    v_mul_f32 v76, s12, v76
    v_mul_f32 v77, s13, v77
    v_mul_f32 v78, s12, v78
    v_mul_f32 v79, s13, v79
    v_mul_f32 v80, s12, v80
    v_mul_f32 v81, s13, v81
    v_mul_f32 v82, s12, v82
    v_mul_f32 v83, s13, v83
    s_waitcnt lgkmcnt(8)
    v_mfma_f32_32x32x16_bf16 v[84:99], v[40:43], v[144:147], v[84:99]
    ds_read_b64_tr_b16 v[36:37], v16 offset:24576
    ds_read_b64_tr_b16 v[38:39], v16 offset:25088
    v_cvt_pk_bf16_f32 v68, v68, v69
    v_cvt_pk_bf16_f32 v69, v70, v71
    v_cvt_pk_bf16_f32 v70, v72, v73
    v_cvt_pk_bf16_f32 v71, v74, v75
    s_waitcnt lgkmcnt(8)
    v_mfma_f32_32x32x16_bf16 v[84:99], v[20:23], v[148:151], v[84:99]
    ds_read_b64_tr_b16 v[40:41], v16 offset:26624
    ds_read_b64_tr_b16 v[42:43], v16 offset:27136
    v_cvt_pk_bf16_f32 v72, v76, v77
    v_cvt_pk_bf16_f32 v73, v78, v79
    v_cvt_pk_bf16_f32 v74, v80, v81
    v_cvt_pk_bf16_f32 v75, v82, v83
    s_waitcnt lgkmcnt(8)
    v_mfma_f32_32x32x16_bf16 v[84:99], v[24:27], v[152:155], v[84:99]
    ds_read_b64_tr_b16 v[20:21], v16 offset:28672
    ds_read_b64_tr_b16 v[22:23], v16 offset:29184
    s_add_u32 s80, s23, 1048576
    s_add_u32 s81, s23, 1114112
    buffer_store_dwordx4 v[68:71], v17, s[44:47], s80 offen sc1
    s_waitcnt lgkmcnt(8)
    v_mfma_f32_32x32x16_bf16 v[84:99], v[28:31], v[156:159], v[84:99]
    ds_read_b64_tr_b16 v[24:25], v16 offset:30720
    ds_read_b64_tr_b16 v[26:27], v16 offset:31232
    buffer_store_dwordx4 v[72:75], v17, s[44:47], s81 offen sc1
    s_waitcnt lgkmcnt(8)
    v_mfma_f32_32x32x16_bf16 v[84:99], v[32:35], v[160:163], v[84:99]
    s_waitcnt vmcnt(4) lgkmcnt(0)
    s_barrier
    ds_read_b64_tr_b16 v[28:29], v15 offset:0
    ds_read_b64_tr_b16 v[30:31], v15 offset:512
    s_mov_b64 exec, 1
    buffer_store_dword v46, v252, s[44:47], s17 offen sc1
    s_mov_b64 exec, -1
    s_waitcnt lgkmcnt(8)
    v_mfma_f32_32x32x16_bf16 v[84:99], v[36:39], v[164:167], v[84:99]
    ds_read_b64_tr_b16 v[32:33], v15 offset:2048
    ds_read_b64_tr_b16 v[34:35], v15 offset:2560
    s_waitcnt lgkmcnt(8)
    v_mfma_f32_32x32x16_bf16 v[84:99], v[40:43], v[168:171], v[84:99]
    ds_read_b64_tr_b16 v[36:37], v15 offset:4096
    ds_read_b64_tr_b16 v[38:39], v15 offset:4608
    s_waitcnt lgkmcnt(8)
    v_mfma_f32_32x32x16_bf16 v[84:99], v[20:23], v[172:175], v[84:99]
    ds_read_b64_tr_b16 v[40:41], v15 offset:6144
    ds_read_b64_tr_b16 v[42:43], v15 offset:6656
    s_waitcnt lgkmcnt(8)
    v_mfma_f32_32x32x16_bf16 v[84:99], v[24:27], v[176:179], v[84:99]
    ds_read_b64_tr_b16 v[20:21], v15 offset:8192
    ds_read_b64_tr_b16 v[22:23], v15 offset:8704
    s_waitcnt lgkmcnt(8)
    v_mfma_f32_32x32x16_bf16 v[84:99], v[28:31], v[180:183], v[84:99]
    ds_read_b64_tr_b16 v[24:25], v15 offset:10240
    ds_read_b64_tr_b16 v[26:27], v15 offset:10752
    s_waitcnt lgkmcnt(8)
    v_mfma_f32_32x32x16_bf16 v[84:99], v[32:35], v[184:187], v[84:99]
    ds_read_b64_tr_b16 v[28:29], v15 offset:12288
    ds_read_b64_tr_b16 v[30:31], v15 offset:12800
    s_waitcnt lgkmcnt(8)
    v_mfma_f32_32x32x16_bf16 v[84:99], v[36:39], v[188:191], v[84:99]
    ds_read_b64_tr_b16 v[32:33], v15 offset:14336
    ds_read_b64_tr_b16 v[34:35], v15 offset:14848
    s_waitcnt lgkmcnt(8)
    v_mfma_f32_32x32x16_bf16 v[84:99], v[40:43], v[192:195], v[84:99]
    ds_read_b64_tr_b16 v[36:37], v15 offset:16384
    ds_read_b64_tr_b16 v[38:39], v15 offset:16896
    s_waitcnt lgkmcnt(8)
    v_mfma_f32_32x32x16_bf16 v[84:99], v[20:23], v[196:199], v[84:99]
    ds_read_b64_tr_b16 v[40:41], v15 offset:18432
    ds_read_b64_tr_b16 v[42:43], v15 offset:18944
    s_waitcnt lgkmcnt(8)
    v_mfma_f32_32x32x16_bf16 v[84:99], v[24:27], v[200:203], v[84:99]
    ds_read_b64_tr_b16 v[20:21], v15 offset:20480
    ds_read_b64_tr_b16 v[22:23], v15 offset:20992
    s_waitcnt lgkmcnt(8)
    v_mfma_f32_32x32x16_bf16 v[84:99], v[28:31], v[204:207], v[84:99]
    ds_read_b64_tr_b16 v[24:25], v15 offset:22528
    ds_read_b64_tr_b16 v[26:27], v15 offset:23040
    s_waitcnt lgkmcnt(8)
    v_mfma_f32_32x32x16_bf16 v[84:99], v[32:35], v[208:211], v[84:99]
    ds_read_b64_tr_b16 v[28:29], v15 offset:24576
    ds_read_b64_tr_b16 v[30:31], v15 offset:25088
    s_waitcnt lgkmcnt(8)
    v_mfma_f32_32x32x16_bf16 v[84:99], v[36:39], v[212:215], v[84:99]
    ds_read_b64_tr_b16 v[32:33], v15 offset:26624
    ds_read_b64_tr_b16 v[34:35], v15 offset:27136
    s_waitcnt lgkmcnt(8)
    v_mfma_f32_32x32x16_bf16 v[84:99], v[40:43], v[216:219], v[84:99]
    ds_read_b64_tr_b16 v[36:37], v15 offset:28672
    ds_read_b64_tr_b16 v[38:39], v15 offset:29184
    s_waitcnt lgkmcnt(8)
    v_mfma_f32_32x32x16_bf16 v[84:99], v[20:23], v[220:223], v[84:99]
    ds_read_b64_tr_b16 v[40:41], v15 offset:30720
    ds_read_b64_tr_b16 v[42:43], v15 offset:31232
    s_waitcnt lgkmcnt(8)
    v_mfma_f32_32x32x16_bf16 v[84:99], v[24:27], v[224:227], v[84:99]
    s_waitcnt lgkmcnt(6)
    v_mfma_f32_32x32x16_bf16 v[84:99], v[28:31], v[228:231], v[84:99]
    s_waitcnt lgkmcnt(4)
    v_mfma_f32_32x32x16_bf16 v[84:99], v[32:35], v[232:235], v[84:99]
    s_waitcnt lgkmcnt(2)
    v_mfma_f32_32x32x16_bf16 v[84:99], v[36:39], v[236:239], v[84:99]
    s_waitcnt lgkmcnt(0)
    v_mfma_f32_32x32x16_bf16 v[84:99], v[40:43], v[240:243], v[84:99]
    ds_write_b128 v247, v[4:7]
    s_waitcnt lgkmcnt(0)
    ds_read_b64_tr_b16 v[108:109], v18 offset:0
    ds_read_b64_tr_b16 v[110:111], v18 offset:256
    ds_read_b64_tr_b16 v[112:113], v18 offset:512
    ds_read_b64_tr_b16 v[114:115], v18 offset:768
    s_setprio 2
    s_nop 2
    s_cmp_ge_u32 s68, 4
    s_cbranch_scc0 L_g1
    s_lshl_b32 s3, s22, 3
    s_add_u32 s3, s3, 19922944
    s_waitcnt vmcnt(0)
    s_mov_b64 exec, 1
    buffer_store_dwordx2 v[250:251], v252, s[44:47], s3 offen sc1
    s_mov_b64 exec, -1
    s_setprio 1
L_g1:
    v_cvt_pk_bf16_f32 v20, v84, v85
    v_cvt_pk_bf16_f32 v21, v86, v87
    v_cvt_pk_bf16_f32 v22, v88, v89
    v_cvt_pk_bf16_f32 v23, v90, v91
    v_cvt_pk_bf16_f32 v24, v92, v93
    v_cvt_pk_bf16_f32 v25, v94, v95
    v_cvt_pk_bf16_f32 v26, v96, v97
    v_cvt_pk_bf16_f32 v27, v98, v99
    s_waitcnt lgkmcnt(0)
    v_xor_b32 v108, v19, v108
    v_xor_b32 v109, v19, v109
    v_xor_b32 v110, v19, v110
    v_xor_b32 v111, v19, v111
    v_xor_b32 v112, v19, v112
    v_xor_b32 v113, v19, v113
    v_xor_b32 v114, v19, v114
    v_xor_b32 v115, v19, v115
    v_mfma_f32_32x32x16_bf16 v[52:67], v[108:111], v[20:23], 0
    s_nop 0
    v_mfma_f32_32x32x16_bf16 v[68:83], v[112:115], v[24:27], 0
    s_lshl_b32 s78, s72, 14
    s_lshl_b32 s79, s73, 12
    s_add_u32 s78, s78, s79
    s_add_u32 s78, s78, 98304
    v_add_u32 v2, s78, v17
    s_nop 4
    v_max3_f32 v8, v52, v53, v54
    v_max3_f32 v9, v60, v61, v62
    v_max3_f32 v8, v8, v55, v56
    v_max3_f32 v9, v9, v63, v64
    v_max3_f32 v8, v8, v57, v58
    v_max3_f32 v9, v9, v65, v66
    v_max_f32 v8, v8, v59
    v_max_f32 v9, v9, v67
    s_nop 1
    v_permlane32_swap_b32 v8, v9
    v_max_f32 v8, v8, v9
    v_mul_f32 v8, s10, v8
    v_mov_b32 v9, v8
    s_nop 1
    v_permlane32_swap_b32 v8, v9
    v_pk_fma_f32 v[52:53], v[52:53], s[10:11], v[8:9] op_sel:[0,0,0] op_sel_hi:[1,1,0] neg_lo:[0,0,1] neg_hi:[0,0,1]
    v_pk_fma_f32 v[54:55], v[54:55], s[10:11], v[8:9] op_sel:[0,0,0] op_sel_hi:[1,1,0] neg_lo:[0,0,1] neg_hi:[0,0,1]
    v_pk_fma_f32 v[56:57], v[56:57], s[10:11], v[8:9] op_sel:[0,0,0] op_sel_hi:[1,1,0] neg_lo:[0,0,1] neg_hi:[0,0,1]
    v_pk_fma_f32 v[58:59], v[58:59], s[10:11], v[8:9] op_sel:[0,0,0] op_sel_hi:[1,1,0] neg_lo:[0,0,1] neg_hi:[0,0,1]
    v_pk_fma_f32 v[60:61], v[60:61], s[10:11], v[8:9] op_sel:[0,0,1] op_sel_hi:[1,1,1] neg_lo:[0,0,1] neg_hi:[0,0,1]
    v_pk_fma_f32 v[62:63], v[62:63], s[10:11], v[8:9] op_sel:[0,0,1] op_sel_hi:[1,1,1] neg_lo:[0,0,1] neg_hi:[0,0,1]
    v_pk_fma_f32 v[64:65], v[64:65], s[10:11], v[8:9] op_sel:[0,0,1] op_sel_hi:[1,1,1] neg_lo:[0,0,1] neg_hi:[0,0,1]
    v_pk_fma_f32 v[66:67], v[66:67], s[10:11], v[8:9] op_sel:[0,0,1] op_sel_hi:[1,1,1] neg_lo:[0,0,1] neg_hi:[0,0,1]
    v_exp_f32 v52, v52
    v_exp_f32 v53, v53
    v_exp_f32 v54, v54
    v_exp_f32 v55, v55
    v_exp_f32 v56, v56
    v_exp_f32 v57, v57
    v_exp_f32 v58, v58
    v_exp_f32 v59, v59
    v_exp_f32 v60, v60
    v_exp_f32 v61, v61
    v_exp_f32 v62, v62
    v_exp_f32 v63, v63
    v_exp_f32 v64, v64
    v_exp_f32 v65, v65
    v_exp_f32 v66, v66
    v_exp_f32 v67, v67
    v_pk_add_f32 v[10:11], v[52:53], v[54:55]
    v_pk_add_f32 v[12:13], v[60:61], v[62:63]
    v_pk_add_f32 v[10:11], v[10:11], v[56:57]
    v_pk_add_f32 v[12:13], v[12:13], v[64:65]
    v_pk_add_f32 v[10:11], v[10:11], v[58:59]
    v_pk_add_f32 v[12:13], v[12:13], v[66:67]
    v_add_f32 v8, v10, v11
    v_add_f32 v9, v12, v13
    s_nop 1
    v_permlane32_swap_b32 v8, v9
    v_add_f32 v8, v8, v9
    v_rcp_f32 v8, v8
    s_nop 0
    v_mov_b32 v9, v8
    s_nop 1
    v_permlane32_swap_b32 v8, v9
    v_pk_mul_f32 v[52:53], v[52:53], v[8:9] op_sel:[0,0] op_sel_hi:[1,0]
    v_pk_mul_f32 v[54:55], v[54:55], v[8:9] op_sel:[0,0] op_sel_hi:[1,0]
    v_pk_mul_f32 v[56:57], v[56:57], v[8:9] op_sel:[0,0] op_sel_hi:[1,0]
    v_pk_mul_f32 v[58:59], v[58:59], v[8:9] op_sel:[0,0] op_sel_hi:[1,0]
    v_pk_mul_f32 v[60:61], v[60:61], v[8:9] op_sel:[0,1] op_sel_hi:[1,1]
    v_pk_mul_f32 v[62:63], v[62:63], v[8:9] op_sel:[0,1] op_sel_hi:[1,1]
    v_pk_mul_f32 v[64:65], v[64:65], v[8:9] op_sel:[0,1] op_sel_hi:[1,1]
    v_pk_mul_f32 v[66:67], v[66:67], v[8:9] op_sel:[0,1] op_sel_hi:[1,1]
    v_cvt_pk_bf16_f32 v28, v52, v53
    v_cvt_pk_bf16_f32 v29, v54, v55
    v_cvt_pk_bf16_f32 v30, v56, v57
    v_cvt_pk_bf16_f32 v31, v58, v59
    v_cvt_pk_bf16_f32 v32, v60, v61
    v_cvt_pk_bf16_f32 v33, v62, v63
    v_cvt_pk_bf16_f32 v34, v64, v65
    v_cvt_pk_bf16_f32 v35, v66, v67
    s_cmp_ge_u32 s68, 4
    s_cbranch_scc1 L_g2
    s_lshl_b32 s3, s22, 3
    s_add_u32 s3, s3, 19922944
    s_waitcnt vmcnt(0)
    s_mov_b64 exec, 1
    buffer_store_dwordx2 v[250:251], v252, s[44:47], s3 offen sc1
    s_mov_b64 exec, -1
L_g2:
    ds_write_b128 v2, v[28:31] offset:0
    ds_write_b128 v2, v[32:35] offset:1024
    v_max3_f32 v8, v68, v69, v70
    v_max3_f32 v9, v76, v77, v78
    v_max3_f32 v8, v8, v71, v72
    v_max3_f32 v9, v9, v79, v80
    v_max3_f32 v8, v8, v73, v74
    v_max3_f32 v9, v9, v81, v82
    v_max_f32 v8, v8, v75
    v_max_f32 v9, v9, v83
    s_nop 1
    v_permlane32_swap_b32 v8, v9
    v_max_f32 v8, v8, v9
    v_mul_f32 v8, s10, v8
    v_mov_b32 v9, v8
    s_nop 1
    v_permlane32_swap_b32 v8, v9
    v_pk_fma_f32 v[68:69], v[68:69], s[10:11], v[8:9] op_sel:[0,0,0] op_sel_hi:[1,1,0] neg_lo:[0,0,1] neg_hi:[0,0,1]
    v_pk_fma_f32 v[70:71], v[70:71], s[10:11], v[8:9] op_sel:[0,0,0] op_sel_hi:[1,1,0] neg_lo:[0,0,1] neg_hi:[0,0,1]
    v_pk_fma_f32 v[72:73], v[72:73], s[10:11], v[8:9] op_sel:[0,0,0] op_sel_hi:[1,1,0] neg_lo:[0,0,1] neg_hi:[0,0,1]
    v_pk_fma_f32 v[74:75], v[74:75], s[10:11], v[8:9] op_sel:[0,0,0] op_sel_hi:[1,1,0] neg_lo:[0,0,1] neg_hi:[0,0,1]
    v_pk_fma_f32 v[76:77], v[76:77], s[10:11], v[8:9] op_sel:[0,0,1] op_sel_hi:[1,1,1] neg_lo:[0,0,1] neg_hi:[0,0,1]
    v_pk_fma_f32 v[78:79], v[78:79], s[10:11], v[8:9] op_sel:[0,0,1] op_sel_hi:[1,1,1] neg_lo:[0,0,1] neg_hi:[0,0,1]
    v_pk_fma_f32 v[80:81], v[80:81], s[10:11], v[8:9] op_sel:[0,0,1] op_sel_hi:[1,1,1] neg_lo:[0,0,1] neg_hi:[0,0,1]
    v_pk_fma_f32 v[82:83], v[82:83], s[10:11], v[8:9] op_sel:[0,0,1] op_sel_hi:[1,1,1] neg_lo:[0,0,1] neg_hi:[0,0,1]
    v_exp_f32 v68, v68
    v_exp_f32 v69, v69
    v_exp_f32 v70, v70
    v_exp_f32 v71, v71
    v_exp_f32 v72, v72
    v_exp_f32 v73, v73
    v_exp_f32 v74, v74
    v_exp_f32 v75, v75
    v_exp_f32 v76, v76
    v_exp_f32 v77, v77
    v_exp_f32 v78, v78
    v_exp_f32 v79, v79
    v_exp_f32 v80, v80
    v_exp_f32 v81, v81
    v_exp_f32 v82, v82
    v_exp_f32 v83, v83
    v_pk_add_f32 v[10:11], v[68:69], v[70:71]
    v_pk_add_f32 v[12:13], v[76:77], v[78:79]
    v_pk_add_f32 v[10:11], v[10:11], v[72:73]
    v_pk_add_f32 v[12:13], v[12:13], v[80:81]
    v_pk_add_f32 v[10:11], v[10:11], v[74:75]
    v_pk_add_f32 v[12:13], v[12:13], v[82:83]
    v_add_f32 v8, v10, v11
    v_add_f32 v9, v12, v13
    s_nop 1
    v_permlane32_swap_b32 v8, v9
    v_add_f32 v8, v8, v9
    v_rcp_f32 v8, v8
    s_nop 0
    v_mov_b32 v9, v8
    s_nop 1
    v_permlane32_swap_b32 v8, v9
    v_pk_mul_f32 v[68:69], v[68:69], v[8:9] op_sel:[0,0] op_sel_hi:[1,0]
    v_pk_mul_f32 v[70:71], v[70:71], v[8:9] op_sel:[0,0] op_sel_hi:[1,0]
    v_pk_mul_f32 v[72:73], v[72:73], v[8:9] op_sel:[0,0] op_sel_hi:[1,0]
    v_pk_mul_f32 v[74:75], v[74:75], v[8:9] op_sel:[0,0] op_sel_hi:[1,0]
    v_pk_mul_f32 v[76:77], v[76:77], v[8:9] op_sel:[0,1] op_sel_hi:[1,1]
    v_pk_mul_f32 v[78:79], v[78:79], v[8:9] op_sel:[0,1] op_sel_hi:[1,1]
    v_pk_mul_f32 v[80:81], v[80:81], v[8:9] op_sel:[0,1] op_sel_hi:[1,1]
    v_pk_mul_f32 v[82:83], v[82:83], v[8:9] op_sel:[0,1] op_sel_hi:[1,1]
    v_cvt_pk_bf16_f32 v36, v68, v69
    v_cvt_pk_bf16_f32 v37, v70, v71
    v_cvt_pk_bf16_f32 v38, v72, v73
    v_cvt_pk_bf16_f32 v39, v74, v75
    v_cvt_pk_bf16_f32 v40, v76, v77
    v_cvt_pk_bf16_f32 v41, v78, v79
    v_cvt_pk_bf16_f32 v42, v80, v81
    v_cvt_pk_bf16_f32 v43, v82, v83
    ds_write_b128 v2, v[36:39] offset:2048
    ds_write_b128 v2, v[40:43] offset:3072
    s_branch L_p1done
L_type2:
    s_mov_b32 s46, 23068672
    s_mov_b32 s47, 0x20000
    s_mov_b32 s54, 2097152
    s_mov_b32 s55, 0x20000
    s_lshr_b32 s78, s2, 3
    s_and_b32 s79, s78, 3
    s_lshl_b32 s74, s89, 2
    s_add_u32 s74, s74, s79
    s_lshr_b32 s75, s78, 2
    s_lshl_b32 s14, s89, 2
    s_and_b32 s79, s78, 1
    s_add_u32 s14, s14, s79
    s_lshl_b32 s14, s14, 1
    s_and_b32 s79, s68, 1
    s_add_u32 s14, s14, s79
    s_lshr_b32 s15, s78, 1
    s_lshl_b32 s15, s15, 6
    s_mov_b32 s16, s72
    s_lshl_b32 s76, s71, 2
    s_add_u32 s76, s76, s72
    s_lshl_b32 s23, s77, 16
    s_lshl_b32 s80, s76, 10
    s_add_u32 s23, s23, s80
    s_lshl_b32 s22, s69, 2
    s_add_u32 s22, s22, s73
    s_lshl_b32 s22, s22, 6
    s_add_u32 s22, s22, s76
    s_lshl_b32 s22, s22, 3
    s_lshl_b32 s80, s70, 10
    s_add_u32 s22, s22, s80
    s_add_u32 s22, s22, 4096
    v_mov_b32 v252, 0
    s_mov_b32 s10, 0x3fb8aa3b
    s_mov_b32 s11, 0x3fb8aa3b
    s_mov_b32 s12, 0x3eb8aa3b
    s_mov_b32 s13, 0x3eb8aa3b
    s_mov_b32 s4, 0xffff
    s_mov_b32 s5, 0xffff
    s_bfe_u32 s79, s74, 0x10001
    s_lshl_b32 s80, s89, 2
    s_add_u32 s80, s80, s79
    s_lshl_b32 s80, s80, 9
    s_add_u32 s80, s80, 4096
    s_lshl_b32 s81, s68, 6
    s_add_u32 s81, s81, s80
    s_lshl_b32 s78, s75, 6
    s_add_u32 s78, s78, s80
    v_and_b32 v18, 7, v1
    v_lshlrev_b32 v18, 3, v18
    v_bfe_u32 v19, v1, 3, 1
    v_lshl_add_u32 v19, v19, 10, v18
    v_add_u32 v19, s81, v19
    v_add_u32 v18, s78, v18
    v_cmp_gt_u32 s[78:79], 16, v1
    s_nop 1
    v_cndmask_b32 v253, v18, v19, s[78:79]
    v_and_b32 v19, 15, v1
    v_lshlrev_b32 v19, 4, v19
    v_lshl_add_u32 v255, v244, 8, v19
    s_lshl_b32 s78, s68, 10
    s_add_u32 s78, s78, 16384
    v_bfe_u32 v18, v1, 2, 2
    v_lshl_add_u32 v18, v244, 2, v18
    v_lshlrev_b32 v18, 5, v18
    v_and_b32 v19, 3, v1
    v_lshl_add_u32 v18, v19, 3, v18
    v_add_u32 v18, s78, v18
    v_bfe_u32 v19, v1, 4, 1
    v_mul_u32_u24 v19, 0x8000, v19
    v_lshl_or_b32 v19, v19, 16, v19
    v_add_u32 v247, s78, v17
    v_bfe_u32 v44, v1, 2, 2
    v_lshl_add_u32 v44, v244, 2, v44
    v_lshlrev_b32 v44, 6, v44
    v_bfe_u32 v45, v1, 4, 1
    v_lshl_add_u32 v44, v45, 5, v44
    v_and_b32 v45, 3, v1
    v_lshl_add_u32 v44, v45, 3, v44
    v_add_u32 v0, 98304, v44
    v_mul_u32_u24 v44, 144, v2
    v_lshl_add_u32 v246, v244, 4, v44
    s_getpc_b64 s[8:9]
L_pcs3:
    s_add_u32 s8, s8, L_slow-L_pcs3
    s_addc_u32 s9, s9, 0
    s_waitcnt lgkmcnt(0)
    s_add_u32 s26, s26, 0x9e3779b9
    s_addc_u32 s27, s27, 0x7f4a7c15
    v_mov_b32 v250, s26
    v_mov_b32 v251, s27
    v_and_b32 v2, 31, v1
    v_lshlrev_b32 v44, 2, v244
    v_sub_u32 v44, v2, v44
    v_mov_b32 v45, 0x3f80
    v_mov_b32 v245, 0x3f800000
    v_cmp_eq_u32 s[78:79], 0, v44
    v_cmp_eq_u32 s[80:81], 1, v44
    s_nop 0
    v_cndmask_b32 v100, 0, v45, s[78:79]
    s_waitcnt vmcnt(5) lgkmcnt(0)
    s_barrier
    ds_read_b128 v[116:119], v11 offset:0
    ds_read_b64_tr_b16 v[20:21], v15 offset:32768
    ds_read_b64_tr_b16 v[22:23], v15 offset:33280
    ds_read_b64_tr_b16 v[24:25], v15 offset:40960
    ds_read_b64_tr_b16 v[26:27], v15 offset:41472
    ds_read_b128 v[120:123], v12 offset:0
    ds_read_b64_tr_b16 v[28:29], v15 offset:34816
    ds_read_b64_tr_b16 v[30:31], v15 offset:35328
    ds_read_b64_tr_b16 v[32:33], v15 offset:43008
    ds_read_b64_tr_b16 v[34:35], v15 offset:43520
    ds_read_b128 v[124:127], v13 offset:0
    ds_read_b64_tr_b16 v[36:37], v15 offset:36864
    ds_read_b64_tr_b16 v[38:39], v15 offset:37376
    s_waitcnt lgkmcnt(10)
    v_mfma_f32_32x32x16_bf16 v[52:67], v[116:119], v[20:23], 0
    s_add_u32 m0, s87, 49152
    ds_read_b64_tr_b16 v[40:41], v15 offset:45056
    ds_read_b64_tr_b16 v[42:43], v15 offset:45568
    buffer_load_dwordx4 v10, s[32:35], s85 offen lds
    v_cndmask_b32 v100, v100, v245, s[80:81]
    v_cmp_eq_u32 s[78:79], 2, v44
    v_cmp_eq_u32 s[80:81], 3, v44
    s_nop 0
    v_cndmask_b32 v101, 0, v45, s[78:79]
    s_waitcnt lgkmcnt(10)
    v_mfma_f32_32x32x16_bf16 v[68:83], v[24:27], v[116:119], 0
    s_add_u32 m0, s87, 57344
    ds_read_b128 v[128:131], v14 offset:0
    ds_read_b64_tr_b16 v[20:21], v15 offset:38912
    ds_read_b64_tr_b16 v[22:23], v15 offset:39424
    buffer_load_dwordx4 v248, s[40:43], s85 offen lds
    s_mul_i32 s85, s18, 196608
    s_add_u32 s85, s85, s20
    v_cndmask_b32 v101, v101, v245, s[80:81]
    v_cmp_eq_u32 s[78:79], 8, v44
    v_cmp_eq_u32 s[80:81], 9, v44
    s_nop 0
    v_cndmask_b32 v102, 0, v45, s[78:79]
    s_waitcnt lgkmcnt(10)
    v_mfma_f32_32x32x16_bf16 v[52:67], v[120:123], v[28:31], v[52:67]
    s_add_u32 m0, s86, 32768
    ds_read_b64_tr_b16 v[24:25], v15 offset:47104
    ds_read_b64_tr_b16 v[26:27], v15 offset:47616
    buffer_load_dwordx4 v8, s[28:31], s84 offen lds
    v_cndmask_b32 v102, v102, v245, s[80:81]
    v_cmp_eq_u32 s[78:79], 10, v44
    v_cmp_eq_u32 s[80:81], 11, v44
    s_nop 0
    v_cndmask_b32 v103, 0, v45, s[78:79]
    s_waitcnt lgkmcnt(10)
    v_mfma_f32_32x32x16_bf16 v[68:83], v[32:35], v[120:123], v[68:83]
    s_waitcnt vmcnt(1)
    s_barrier
    ds_read_b128 v[132:135], v11 offset:16384
    ds_read_b64_tr_b16 v[28:29], v15 offset:49152
    ds_read_b64_tr_b16 v[30:31], v15 offset:49664
    buffer_load_dwordx4 v9, s[28:31], s84 offen offset:1024 lds
    s_add_u32 s18, s18, 1
    s_and_b32 s18, s18, 7
    s_lshl_b32 s84, s18, 7
    s_add_u32 s84, s84, s19
    v_cndmask_b32 v103, v103, v245, s[80:81]
    v_cmp_eq_u32 s[78:79], 16, v44
    v_cmp_eq_u32 s[80:81], 17, v44
    s_nop 0
    v_cndmask_b32 v104, 0, v45, s[78:79]
    s_waitcnt lgkmcnt(10)
    v_mfma_f32_32x32x16_bf16 v[52:67], v[124:127], v[36:39], v[52:67]
    s_add_u32 m0, s87, 65536
    ds_read_b64_tr_b16 v[32:33], v15 offset:57344
    ds_read_b64_tr_b16 v[34:35], v15 offset:57856
    buffer_load_dwordx4 v10, s[32:35], s85 offen lds
    v_cndmask_b32 v104, v104, v245, s[80:81]
    v_cmp_eq_u32 s[78:79], 18, v44
    v_cmp_eq_u32 s[80:81], 19, v44
    s_nop 0
    v_cndmask_b32 v105, 0, v45, s[78:79]
    s_waitcnt lgkmcnt(10)
    v_mfma_f32_32x32x16_bf16 v[68:83], v[40:43], v[124:127], v[68:83]
    s_add_u32 m0, s87, 73728
    ds_read_b128 v[136:139], v12 offset:16384
    ds_read_b64_tr_b16 v[36:37], v15 offset:51200
    ds_read_b64_tr_b16 v[38:39], v15 offset:51712
    buffer_load_dwordx4 v248, s[40:43], s85 offen lds
    s_mul_i32 s85, s18, 196608
    s_add_u32 s85, s85, s20
    v_cndmask_b32 v105, v105, v245, s[80:81]
    v_cmp_eq_u32 s[78:79], 24, v44
    v_cmp_eq_u32 s[80:81], 25, v44
    s_nop 0
    v_cndmask_b32 v106, 0, v45, s[78:79]
    s_waitcnt lgkmcnt(10)
    v_mfma_f32_32x32x16_bf16 v[52:67], v[128:131], v[20:23], v[52:67]
    s_add_u32 m0, s86, 49152
    ds_read_b64_tr_b16 v[40:41], v15 offset:59392
    ds_read_b64_tr_b16 v[42:43], v15 offset:59904
    buffer_load_dwordx4 v8, s[28:31], s84 offen lds
    v_cndmask_b32 v106, v106, v245, s[80:81]
    v_cmp_eq_u32 s[78:79], 26, v44
    v_cmp_eq_u32 s[80:81], 27, v44
    s_nop 0
    v_cndmask_b32 v107, 0, v45, s[78:79]
    s_waitcnt lgkmcnt(10)
    v_mfma_f32_32x32x16_bf16 v[68:83], v[24:27], v[128:131], v[68:83]
    ds_read_b128 v[140:143], v13 offset:16384
    ds_read_b64_tr_b16 v[20:21], v15 offset:53248
    ds_read_b64_tr_b16 v[22:23], v15 offset:53760
    v_cndmask_b32 v107, v107, v245, s[80:81]
    v_bfe_u32 v44, v1, 4, 1
    v_lshlrev_b32 v44, 16, v44
    v_lshl_add_u32 v44, v244, 8, v44
    s_waitcnt lgkmcnt(10)
    v_mfma_f32_32x32x16_bf16 v[52:67], v[132:135], v[28:31], v[52:67]
    ds_read_b64_tr_b16 v[24:25], v15 offset:61440
    ds_read_b64_tr_b16 v[26:27], v15 offset:61952
    buffer_load_dwordx4 v9, s[28:31], s84 offen offset:1024 lds
    s_add_u32 s18, s18, 1
    s_and_b32 s18, s18, 7
    s_lshl_b32 s84, s18, 7
    s_add_u32 s84, s84, s19
    v_and_b32 v45, 15, v1
    v_lshl_add_u32 v254, v45, 4, v44
    s_waitcnt lgkmcnt(10)
    v_mfma_f32_32x32x16_bf16 v[68:83], v[32:35], v[132:135], v[68:83]
    ds_read_b128 v[144:147], v14 offset:16384
    ds_read_b64_tr_b16 v[28:29], v15 offset:55296
    ds_read_b64_tr_b16 v[30:31], v15 offset:55808
    v_dot2_f32_bf16 v46, v108, v112, 0
    v_dot2_f32_bf16 v47, v109, v113, 0
    s_waitcnt lgkmcnt(10)
    v_mfma_f32_32x32x16_bf16 v[52:67], v[136:139], v[36:39], v[52:67]
    s_add_u32 m0, s87, 81920
    ds_read_b64_tr_b16 v[32:33], v15 offset:63488
    ds_read_b64_tr_b16 v[34:35], v15 offset:64000
    buffer_load_dwordx4 v10, s[32:35], s85 offen lds
    s_waitcnt lgkmcnt(10)
    v_mfma_f32_32x32x16_bf16 v[68:83], v[40:43], v[136:139], v[68:83]
    s_waitcnt vmcnt(3)
    s_barrier
    s_add_u32 m0, s87, 90112
    ds_read_b128 v[148:151], v11 offset:32768
    ds_read_b64_tr_b16 v[36:37], v16 offset:0
    ds_read_b64_tr_b16 v[38:39], v16 offset:512
    buffer_load_dwordx4 v248, s[40:43], s85 offen lds
    s_mul_i32 s85, s18, 196608
    s_add_u32 s85, s85, s20
    s_waitcnt lgkmcnt(10)
    v_mfma_f32_32x32x16_bf16 v[52:67], v[140:143], v[20:23], v[52:67]
    s_add_u32 m0, s86, 0
    ds_read_b64_tr_b16 v[40:41], v16 offset:8192
    ds_read_b64_tr_b16 v[42:43], v16 offset:8704
    buffer_load_dwordx4 v8, s[28:31], s84 offen lds
    s_waitcnt lgkmcnt(10)
    v_mfma_f32_32x32x16_bf16 v[68:83], v[24:27], v[140:143], v[68:83]
    ds_read_b128 v[152:155], v12 offset:32768
    ds_read_b64_tr_b16 v[20:21], v16 offset:2048
    ds_read_b64_tr_b16 v[22:23], v16 offset:2560
    v_dot2_f32_bf16 v46, v110, v114, v46
    v_dot2_f32_bf16 v47, v111, v115, v47
    s_waitcnt lgkmcnt(10)
    v_mfma_f32_32x32x16_bf16 v[52:67], v[144:147], v[28:31], v[52:67]
    ds_read_b64_tr_b16 v[24:25], v16 offset:10240
    ds_read_b64_tr_b16 v[26:27], v16 offset:10752
    buffer_load_dwordx4 v9, s[28:31], s84 offen offset:1024 lds
    s_add_u32 s18, s18, 1
    s_and_b32 s18, s18, 7
    s_lshl_b32 s84, s18, 7
    s_add_u32 s84, s84, s19
    s_waitcnt lgkmcnt(10)
    v_mfma_f32_32x32x16_bf16 v[68:83], v[32:35], v[144:147], v[68:83]
    ds_read_b128 v[156:159], v13 offset:32768
    ds_read_b64_tr_b16 v[28:29], v16 offset:4096
    ds_read_b64_tr_b16 v[30:31], v16 offset:4608
    s_lshl_b32 s17, s17, 2
    s_add_u32 s17, s17, 131072
    s_waitcnt lgkmcnt(10)
    v_mfma_f32_32x32x16_bf16 v[52:67], v[148:151], v[36:39], v[52:67]
    s_add_u32 m0, s87, 0
    ds_read_b64_tr_b16 v[32:33], v16 offset:12288
    ds_read_b64_tr_b16 v[34:35], v16 offset:12800
    buffer_load_dwordx4 v10, s[32:35], s85 offen lds
    s_waitcnt lgkmcnt(10)
    v_mfma_f32_32x32x16_bf16 v[68:83], v[40:43], v[148:151], v[68:83]
    ds_read_b128 v[160:163], v14 offset:32768
    ds_read_b64_tr_b16 v[36:37], v16 offset:6144
    ds_read_b64_tr_b16 v[38:39], v16 offset:6656
    v_add_f32 v46, v46, v47
    s_waitcnt lgkmcnt(10)
    v_mfma_f32_32x32x16_bf16 v[52:67], v[152:155], v[20:23], v[52:67]
    s_add_u32 m0, s87, 8192
    ds_read_b64_tr_b16 v[40:41], v16 offset:14336
    ds_read_b64_tr_b16 v[42:43], v16 offset:14848
    buffer_load_dwordx4 v248, s[40:43], s85 offen lds
    s_mul_i32 s85, s18, 196608
    s_add_u32 s85, s85, s20
    s_waitcnt lgkmcnt(10)
    v_mfma_f32_32x32x16_bf16 v[68:83], v[24:27], v[152:155], v[68:83]
    s_waitcnt vmcnt(4)
    s_barrier
    ds_read_b128 v[164:167], v11 offset:49152
    ds_read_b64_tr_b16 v[20:21], v16 offset:16384
    ds_read_b64_tr_b16 v[22:23], v16 offset:16896
    v_add_f32_dpp v46, v46, v46 quad_perm:[1,0,3,2] row_mask:0xf bank_mask:0xf
    s_waitcnt lgkmcnt(10)
    v_mfma_f32_32x32x16_bf16 v[52:67], v[156:159], v[28:31], v[52:67]
    s_add_u32 m0, s86, 16384
    ds_read_b64_tr_b16 v[24:25], v16 offset:24576
    ds_read_b64_tr_b16 v[26:27], v16 offset:25088
    buffer_load_dwordx4 v8, s[28:31], s84 offen lds
    s_waitcnt lgkmcnt(10)
    v_mfma_f32_32x32x16_bf16 v[68:83], v[32:35], v[156:159], v[68:83]
    ds_read_b128 v[168:171], v12 offset:49152
    ds_read_b64_tr_b16 v[28:29], v16 offset:18432
    ds_read_b64_tr_b16 v[30:31], v16 offset:18944
    v_add_f32_dpp v46, v46, v46 quad_perm:[2,3,0,1] row_mask:0xf bank_mask:0xf
    s_waitcnt lgkmcnt(10)
    v_mfma_f32_32x32x16_bf16 v[52:67], v[160:163], v[36:39], v[52:67]
    ds_read_b64_tr_b16 v[32:33], v16 offset:26624
    ds_read_b64_tr_b16 v[34:35], v16 offset:27136
    buffer_load_dwordx4 v9, s[28:31], s84 offen offset:1024 lds
    s_add_u32 s18, s18, 1
    s_and_b32 s18, s18, 7
    s_lshl_b32 s84, s18, 7
    s_add_u32 s84, s84, s19
    s_waitcnt lgkmcnt(10)
    v_mfma_f32_32x32x16_bf16 v[68:83], v[40:43], v[160:163], v[68:83]
    ds_read_b128 v[172:175], v13 offset:49152
    ds_read_b64_tr_b16 v[36:37], v16 offset:20480
    ds_read_b64_tr_b16 v[38:39], v16 offset:20992
    v_add_f32_dpp v46, v46, v46 row_half_mirror row_mask:0xf bank_mask:0xf
    s_waitcnt lgkmcnt(10)
    v_mfma_f32_32x32x16_bf16 v[52:67], v[164:167], v[20:23], v[52:67]
    s_add_u32 m0, s87, 16384
    ds_read_b64_tr_b16 v[40:41], v16 offset:28672
    ds_read_b64_tr_b16 v[42:43], v16 offset:29184
    buffer_load_dwordx4 v10, s[32:35], s85 offen lds
    s_waitcnt lgkmcnt(10)
    v_mfma_f32_32x32x16_bf16 v[68:83], v[24:27], v[164:167], v[68:83]
    ds_read_b128 v[176:179], v14 offset:49152
    ds_read_b64_tr_b16 v[20:21], v16 offset:22528
    ds_read_b64_tr_b16 v[22:23], v16 offset:23040
    v_add_f32_dpp v46, v46, v46 row_mirror row_mask:0xf bank_mask:0xf
    s_waitcnt lgkmcnt(10)
    v_mfma_f32_32x32x16_bf16 v[52:67], v[168:171], v[28:31], v[52:67]
    s_add_u32 m0, s87, 24576
    ds_read_b64_tr_b16 v[24:25], v16 offset:30720
    ds_read_b64_tr_b16 v[26:27], v16 offset:31232
    buffer_load_dwordx4 v248, s[40:43], s85 offen lds
    s_mul_i32 s85, s18, 196608
    s_add_u32 s85, s85, s20
    s_waitcnt lgkmcnt(10)
    v_mfma_f32_32x32x16_bf16 v[68:83], v[32:35], v[168:171], v[68:83]
    s_waitcnt vmcnt(4)
    s_barrier
    ds_read_b128 v[180:183], v11 offset:0
    ds_read_b64_tr_b16 v[28:29], v15 offset:0
    ds_read_b64_tr_b16 v[30:31], v15 offset:512
    v_mov_b32 v47, v46
    s_waitcnt lgkmcnt(10)
    v_mfma_f32_32x32x16_bf16 v[52:67], v[172:175], v[36:39], v[52:67]
    s_add_u32 m0, s86, 32768
    ds_read_b64_tr_b16 v[32:33], v15 offset:8192
    ds_read_b64_tr_b16 v[34:35], v15 offset:8704
    buffer_load_dwordx4 v8, s[28:31], s84 offen lds
    s_waitcnt lgkmcnt(10)
    v_mfma_f32_32x32x16_bf16 v[68:83], v[40:43], v[172:175], v[68:83]
    ds_read_b128 v[184:187], v12 offset:0
    ds_read_b64_tr_b16 v[36:37], v15 offset:2048
    ds_read_b64_tr_b16 v[38:39], v15 offset:2560
    v_permlane16_swap_b32 v46, v47
    s_waitcnt lgkmcnt(10)
    v_mfma_f32_32x32x16_bf16 v[52:67], v[176:179], v[20:23], v[52:67]
    ds_read_b64_tr_b16 v[40:41], v15 offset:10240
    ds_read_b64_tr_b16 v[42:43], v15 offset:10752
    buffer_load_dwordx4 v9, s[28:31], s84 offen offset:1024 lds
    s_add_u32 s18, s18, 1
    s_and_b32 s18, s18, 7
    s_lshl_b32 s84, s18, 7
    s_add_u32 s84, s84, s19
    s_waitcnt lgkmcnt(10)
    v_mfma_f32_32x32x16_bf16 v[68:83], v[24:27], v[176:179], v[68:83]
    ds_read_b128 v[188:191], v13 offset:0
    ds_read_b64_tr_b16 v[20:21], v15 offset:4096
    ds_read_b64_tr_b16 v[22:23], v15 offset:4608
    v_add_f32 v46, v46, v47
    v_mov_b32 v47, v46
    s_waitcnt lgkmcnt(10)
    v_mfma_f32_32x32x16_bf16 v[52:67], v[180:183], v[28:31], v[52:67]
    s_add_u32 m0, s87, 32768
    ds_read_b64_tr_b16 v[24:25], v15 offset:12288
    ds_read_b64_tr_b16 v[26:27], v15 offset:12800
    buffer_load_dwordx4 v10, s[32:35], s85 offen lds
    s_waitcnt lgkmcnt(10)
    v_mfma_f32_32x32x16_bf16 v[68:83], v[32:35], v[180:183], v[68:83]
    ds_read_b128 v[192:195], v14 offset:0
    ds_read_b64_tr_b16 v[28:29], v15 offset:6144
    ds_read_b64_tr_b16 v[30:31], v15 offset:6656
    v_permlane32_swap_b32 v46, v47
    s_waitcnt lgkmcnt(10)
    v_mfma_f32_32x32x16_bf16 v[52:67], v[184:187], v[36:39], v[52:67]
    s_add_u32 m0, s87, 40960
    ds_read_b64_tr_b16 v[32:33], v15 offset:14336
    ds_read_b64_tr_b16 v[34:35], v15 offset:14848
    buffer_load_dwordx4 v248, s[40:43], s85 offen lds
    s_mul_i32 s85, s18, 196608
    s_add_u32 s85, s85, s20
    s_waitcnt lgkmcnt(10)
    v_mfma_f32_32x32x16_bf16 v[68:83], v[40:43], v[184:187], v[68:83]
    s_waitcnt vmcnt(4)
    s_barrier
    ds_read_b128 v[196:199], v11 offset:16384
    ds_read_b64_tr_b16 v[36:37], v15 offset:16384
    ds_read_b64_tr_b16 v[38:39], v15 offset:16896
    v_add_f32 v46, v46, v47
    v_mul_f32 v46, s10, v46
    s_waitcnt lgkmcnt(10)
    v_mfma_f32_32x32x16_bf16 v[52:67], v[188:191], v[20:23], v[52:67]
    s_add_u32 m0, s86, 49152
    ds_read_b64_tr_b16 v[40:41], v15 offset:24576
    ds_read_b64_tr_b16 v[42:43], v15 offset:25088
    buffer_load_dwordx4 v8, s[28:31], s84 offen lds
    s_waitcnt lgkmcnt(10)
    v_mfma_f32_32x32x16_bf16 v[68:83], v[24:27], v[188:191], v[68:83]
    ds_read_b128 v[200:203], v12 offset:16384
    ds_read_b64_tr_b16 v[20:21], v15 offset:18432
    ds_read_b64_tr_b16 v[22:23], v15 offset:18944
    v_exp_f32 v46, -v46
    s_waitcnt lgkmcnt(10)
    v_mfma_f32_32x32x16_bf16 v[52:67], v[192:195], v[28:31], v[52:67]
    ds_read_b64_tr_b16 v[24:25], v15 offset:26624
    ds_read_b64_tr_b16 v[26:27], v15 offset:27136
    buffer_load_dwordx4 v9, s[28:31], s84 offen offset:1024 lds
    s_add_u32 s18, s18, 1
    s_and_b32 s18, s18, 7
    s_lshl_b32 s84, s18, 7
    s_add_u32 s84, s84, s19
    s_waitcnt lgkmcnt(10)
    v_mfma_f32_32x32x16_bf16 v[68:83], v[32:35], v[192:195], v[68:83]
    ds_read_b128 v[204:207], v13 offset:16384
    ds_read_b64_tr_b16 v[28:29], v15 offset:20480
    ds_read_b64_tr_b16 v[30:31], v15 offset:20992
    v_add_f32 v46, 1.0, v46
    s_waitcnt lgkmcnt(10)
    v_mfma_f32_32x32x16_bf16 v[52:67], v[196:199], v[36:39], v[52:67]
    s_add_u32 m0, s87, 49152
    ds_read_b64_tr_b16 v[32:33], v15 offset:28672
    ds_read_b64_tr_b16 v[34:35], v15 offset:29184
    buffer_load_dwordx4 v10, s[32:35], s85 offen lds
    v_rcp_f32 v46, v46
    s_waitcnt lgkmcnt(10)
    v_mfma_f32_32x32x16_bf16 v[68:83], v[40:43], v[196:199], v[68:83]
    ds_read_b128 v[208:211], v14 offset:16384
    ds_read_b64_tr_b16 v[36:37], v15 offset:22528
    ds_read_b64_tr_b16 v[38:39], v15 offset:23040
    s_waitcnt lgkmcnt(10)
    v_mfma_f32_32x32x16_bf16 v[52:67], v[200:203], v[20:23], v[52:67]
    s_add_u32 m0, s87, 57344
    ds_read_b64_tr_b16 v[40:41], v15 offset:30720
    ds_read_b64_tr_b16 v[42:43], v15 offset:31232
    buffer_load_dwordx4 v248, s[40:43], s85 offen lds
    s_mul_i32 s85, s18, 196608
    s_add_u32 s85, s85, s20
    s_waitcnt lgkmcnt(10)
    v_mfma_f32_32x32x16_bf16 v[68:83], v[24:27], v[200:203], v[68:83]
    s_waitcnt vmcnt(4)
    s_barrier
    ds_read_b128 v[212:215], v11 offset:32768
    ds_read_b64_tr_b16 v[20:21], v15 offset:32768
    ds_read_b64_tr_b16 v[22:23], v15 offset:33280
    s_waitcnt lgkmcnt(10)
    v_mfma_f32_32x32x16_bf16 v[52:67], v[204:207], v[28:31], v[52:67]
    s_add_u32 m0, s87, 65536
    ds_read_b64_tr_b16 v[24:25], v15 offset:40960
    ds_read_b64_tr_b16 v[26:27], v15 offset:41472
    buffer_load_dwordx4 v249, s[36:39], s85 offen lds
    s_add_u32 s18, s18, 1
    s_and_b32 s18, s18, 7
    s_mul_i32 s85, s18, 196608
    s_add_u32 s85, s85, s20
    s_waitcnt lgkmcnt(10)
    v_mfma_f32_32x32x16_bf16 v[68:83], v[32:35], v[204:207], v[68:83]
    ds_read_b128 v[216:219], v12 offset:32768
    ds_read_b64_tr_b16 v[28:29], v15 offset:34816
    ds_read_b64_tr_b16 v[30:31], v15 offset:35328
    s_waitcnt lgkmcnt(10)
    v_mfma_f32_32x32x16_bf16 v[52:67], v[208:211], v[36:39], v[52:67]
    s_add_u32 m0, s87, 73728
    ds_read_b64_tr_b16 v[32:33], v15 offset:43008
    ds_read_b64_tr_b16 v[34:35], v15 offset:43520
    buffer_load_dwordx4 v249, s[36:39], s85 offen lds
    s_add_u32 s18, s18, 1
    s_and_b32 s18, s18, 7
    s_mul_i32 s85, s18, 196608
    s_add_u32 s85, s85, s20
    s_waitcnt lgkmcnt(10)
    v_mfma_f32_32x32x16_bf16 v[68:83], v[40:43], v[208:211], v[68:83]
    ds_read_b128 v[220:223], v13 offset:32768
    ds_read_b64_tr_b16 v[36:37], v15 offset:36864
    ds_read_b64_tr_b16 v[38:39], v15 offset:37376
    s_waitcnt lgkmcnt(10)
    v_mfma_f32_32x32x16_bf16 v[52:67], v[212:215], v[20:23], v[52:67]
    s_add_u32 m0, s87, 81920
    ds_read_b64_tr_b16 v[40:41], v15 offset:45056
    ds_read_b64_tr_b16 v[42:43], v15 offset:45568
    buffer_load_dwordx4 v249, s[36:39], s85 offen lds
    s_add_u32 s18, s18, 1
    s_and_b32 s18, s18, 7
    s_mul_i32 s85, s18, 196608
    s_add_u32 s85, s85, s20
    s_waitcnt lgkmcnt(10)
    v_mfma_f32_32x32x16_bf16 v[68:83], v[24:27], v[212:215], v[68:83]
    s_add_u32 m0, s87, 90112
    ds_read_b128 v[224:227], v14 offset:32768
    ds_read_b64_tr_b16 v[20:21], v15 offset:38912
    ds_read_b64_tr_b16 v[22:23], v15 offset:39424
    buffer_load_dwordx4 v249, s[36:39], s85 offen lds
    s_add_u32 s18, s18, 1
    s_and_b32 s18, s18, 7
    s_mul_i32 s85, s18, 196608
    s_add_u32 s85, s85, s20
    s_waitcnt lgkmcnt(10)
    v_mfma_f32_32x32x16_bf16 v[52:67], v[216:219], v[28:31], v[52:67]
    s_add_u32 m0, s87, 0
    ds_read_b64_tr_b16 v[24:25], v15 offset:47104
    ds_read_b64_tr_b16 v[26:27], v15 offset:47616
    buffer_load_dwordx4 v249, s[36:39], s85 offen lds
    s_add_u32 s18, s18, 1
    s_and_b32 s18, s18, 7
    s_mul_i32 s85, s18, 196608
    s_add_u32 s85, s85, s20
    s_waitcnt lgkmcnt(10)
    v_mfma_f32_32x32x16_bf16 v[68:83], v[32:35], v[216:219], v[68:83]
    s_waitcnt vmcnt(5)
    s_barrier
    s_add_u32 m0, s87, 8192
    ds_read_b128 v[228:231], v11 offset:49152
    ds_read_b64_tr_b16 v[28:29], v15 offset:49152
    ds_read_b64_tr_b16 v[30:31], v15 offset:49664
    buffer_load_dwordx4 v249, s[36:39], s85 offen lds
    s_add_u32 s18, s18, 1
    s_and_b32 s18, s18, 7
    s_mul_i32 s85, s18, 196608
    s_add_u32 s85, s85, s20
    s_waitcnt lgkmcnt(10)
    v_mfma_f32_32x32x16_bf16 v[52:67], v[220:223], v[36:39], v[52:67]
    s_add_u32 m0, s87, 16384
    ds_read_b64_tr_b16 v[32:33], v15 offset:57344
    ds_read_b64_tr_b16 v[34:35], v15 offset:57856
    buffer_load_dwordx4 v249, s[36:39], s85 offen lds
    s_add_u32 s18, s18, 1
    s_and_b32 s18, s18, 7
    s_mul_i32 s85, s18, 196608
    s_add_u32 s85, s85, s20
    s_waitcnt lgkmcnt(10)
    v_mfma_f32_32x32x16_bf16 v[68:83], v[40:43], v[220:223], v[68:83]
    s_add_u32 m0, s87, 24576
    ds_read_b128 v[232:235], v12 offset:49152
    ds_read_b64_tr_b16 v[36:37], v15 offset:51200
    ds_read_b64_tr_b16 v[38:39], v15 offset:51712
    buffer_load_dwordx4 v249, s[36:39], s85 offen lds
    s_add_u32 s18, s18, 1
    s_and_b32 s18, s18, 7
    s_mul_i32 s85, s18, 196608
    s_add_u32 s85, s85, s20
    s_waitcnt lgkmcnt(10)
    v_mfma_f32_32x32x16_bf16 v[52:67], v[224:227], v[20:23], v[52:67]
    ds_read_b64_tr_b16 v[40:41], v15 offset:59392
    ds_read_b64_tr_b16 v[42:43], v15 offset:59904
    s_waitcnt lgkmcnt(10)
    v_mfma_f32_32x32x16_bf16 v[68:83], v[24:27], v[224:227], v[68:83]
    ds_read_b128 v[236:239], v13 offset:49152
    ds_read_b64_tr_b16 v[20:21], v15 offset:53248
    ds_read_b64_tr_b16 v[22:23], v15 offset:53760
    s_waitcnt lgkmcnt(10)
    v_mfma_f32_32x32x16_bf16 v[52:67], v[228:231], v[28:31], v[52:67]
    ds_read_b64_tr_b16 v[24:25], v15 offset:61440
    ds_read_b64_tr_b16 v[26:27], v15 offset:61952
    s_waitcnt lgkmcnt(10)
    v_mfma_f32_32x32x16_bf16 v[68:83], v[32:35], v[228:231], v[68:83]
    ds_read_b128 v[240:243], v14 offset:49152
    ds_read_b64_tr_b16 v[28:29], v15 offset:55296
    ds_read_b64_tr_b16 v[30:31], v15 offset:55808
    s_waitcnt lgkmcnt(10)
    v_mfma_f32_32x32x16_bf16 v[52:67], v[232:235], v[36:39], v[52:67]
    ds_read_b64_tr_b16 v[32:33], v15 offset:63488
    ds_read_b64_tr_b16 v[34:35], v15 offset:64000
    s_waitcnt lgkmcnt(10)
    v_mfma_f32_32x32x16_bf16 v[68:83], v[40:43], v[232:235], v[68:83]
    s_waitcnt vmcnt(6)
    s_barrier
    ds_read_b64_tr_b16 v[36:37], v16 offset:0
    ds_read_b64_tr_b16 v[38:39], v16 offset:512
    s_waitcnt lgkmcnt(9)
    v_mfma_f32_32x32x16_bf16 v[52:67], v[236:239], v[20:23], v[52:67]
    ds_read_b64_tr_b16 v[40:41], v16 offset:2048
    ds_read_b64_tr_b16 v[42:43], v16 offset:2560
    s_waitcnt lgkmcnt(9)
    v_mfma_f32_32x32x16_bf16 v[68:83], v[24:27], v[236:239], v[68:83]
    ds_read_b64_tr_b16 v[20:21], v16 offset:4096
    ds_read_b64_tr_b16 v[22:23], v16 offset:4608
    s_waitcnt lgkmcnt(8)
    v_mfma_f32_32x32x16_bf16 v[52:67], v[240:243], v[28:31], v[52:67]
    ds_read_b64_tr_b16 v[24:25], v16 offset:6144
    ds_read_b64_tr_b16 v[26:27], v16 offset:6656
    s_cmp_ge_u32 s16, 2
    s_cselect_b32 s40, s56, s60
    s_cselect_b32 s41, s57, s61
    s_mov_b32 s42, 524288
    s_waitcnt lgkmcnt(8)
    v_mfma_f32_32x32x16_bf16 v[68:83], v[32:35], v[240:243], v[68:83]
    ds_read_b64_tr_b16 v[28:29], v16 offset:8192
    ds_read_b64_tr_b16 v[30:31], v16 offset:8704
    s_waitcnt lgkmcnt(8)
    v_mfma_f32_32x32x16_bf16 v[84:99], v[116:119], v[36:39], 0
    ds_read_b64_tr_b16 v[32:33], v16 offset:10240
    ds_read_b64_tr_b16 v[34:35], v16 offset:10752
    s_waitcnt lgkmcnt(8)
    v_mfma_f32_32x32x16_bf16 v[84:99], v[120:123], v[40:43], v[84:99]
    ds_read_b64_tr_b16 v[36:37], v16 offset:12288
    ds_read_b64_tr_b16 v[38:39], v16 offset:12800
    v_cvt_pk_bf16_f32 v52, v52, v53
    v_cvt_pk_bf16_f32 v53, v54, v55
    v_cvt_pk_bf16_f32 v54, v56, v57
    v_cvt_pk_bf16_f32 v55, v58, v59
    s_waitcnt lgkmcnt(8)
    v_mfma_f32_32x32x16_bf16 v[84:99], v[124:127], v[20:23], v[84:99]
    ds_read_b64_tr_b16 v[40:41], v16 offset:14336
    ds_read_b64_tr_b16 v[42:43], v16 offset:14848
    v_cvt_pk_bf16_f32 v56, v60, v61
    v_cvt_pk_bf16_f32 v57, v62, v63
    v_cvt_pk_bf16_f32 v58, v64, v65
    v_cvt_pk_bf16_f32 v59, v66, v67
    s_waitcnt lgkmcnt(8)
    v_mfma_f32_32x32x16_bf16 v[84:99], v[128:131], v[24:27], v[84:99]
    s_waitcnt vmcnt(4)
    s_barrier
    ds_read_b64_tr_b16 v[20:21], v16 offset:16384
    ds_read_b64_tr_b16 v[22:23], v16 offset:16896
    s_add_u32 s80, s23, 5242880
    buffer_store_dwordx4 v[52:55], v254, s[44:47], s80 offen sc1
    s_waitcnt lgkmcnt(8)
    v_mfma_f32_32x32x16_bf16 v[84:99], v[132:135], v[28:31], v[84:99]
    ds_read_b64_tr_b16 v[24:25], v16 offset:18432
    ds_read_b64_tr_b16 v[26:27], v16 offset:18944
    buffer_store_dwordx4 v[56:59], v254, s[44:47], s80 offen offset:512 sc1
    s_waitcnt lgkmcnt(8)
    v_mfma_f32_32x32x16_bf16 v[84:99], v[136:139], v[32:35], v[84:99]
    ds_read_b64_tr_b16 v[28:29], v16 offset:20480
    ds_read_b64_tr_b16 v[30:31], v16 offset:20992
    v_cvt_pk_bf16_f32 v68, v68, v69
    v_cvt_pk_bf16_f32 v69, v70, v71
    v_cvt_pk_bf16_f32 v70, v72, v73
    v_cvt_pk_bf16_f32 v71, v74, v75
    s_waitcnt lgkmcnt(8)
    v_mfma_f32_32x32x16_bf16 v[84:99], v[140:143], v[36:39], v[84:99]
    ds_read_b64_tr_b16 v[32:33], v16 offset:22528
    ds_read_b64_tr_b16 v[34:35], v16 offset:23040
    v_cvt_pk_bf16_f32 v72, v76, v77
    v_cvt_pk_bf16_f32 v73, v78, v79
    v_cvt_pk_bf16_f32 v74, v80, v81
    v_cvt_pk_bf16_f32 v75, v82, v83
    s_waitcnt lgkmcnt(8)
    v_mfma_f32_32x32x16_bf16 v[84:99], v[144:147], v[40:43], v[84:99]
    ds_read_b64_tr_b16 v[36:37], v16 offset:24576
    ds_read_b64_tr_b16 v[38:39], v16 offset:25088
    s_mov_b64 exec, 1
    buffer_store_dword v46, v252, s[44:47], s17 offen sc1
    s_mov_b64 exec, -1
    s_waitcnt lgkmcnt(8)
    v_mfma_f32_32x32x16_bf16 v[84:99], v[148:151], v[20:23], v[84:99]
    ds_read_b64_tr_b16 v[40:41], v16 offset:26624
    ds_read_b64_tr_b16 v[42:43], v16 offset:27136
    s_waitcnt lgkmcnt(8)
    v_mfma_f32_32x32x16_bf16 v[84:99], v[152:155], v[24:27], v[84:99]
    ds_read_b64_tr_b16 v[20:21], v16 offset:28672
    ds_read_b64_tr_b16 v[22:23], v16 offset:29184
    s_waitcnt lgkmcnt(8)
    v_mfma_f32_32x32x16_bf16 v[84:99], v[156:159], v[28:31], v[84:99]
    ds_read_b64_tr_b16 v[24:25], v16 offset:30720
    ds_read_b64_tr_b16 v[26:27], v16 offset:31232
    s_waitcnt lgkmcnt(8)
    v_mfma_f32_32x32x16_bf16 v[84:99], v[160:163], v[32:35], v[84:99]
    s_waitcnt vmcnt(3) lgkmcnt(0)
    s_barrier
    ds_read_b64_tr_b16 v[28:29], v15 offset:0
    ds_read_b64_tr_b16 v[30:31], v15 offset:512
    s_waitcnt lgkmcnt(8)
    v_mfma_f32_32x32x16_bf16 v[84:99], v[164:167], v[36:39], v[84:99]
    ds_read_b64_tr_b16 v[32:33], v15 offset:2048
    ds_read_b64_tr_b16 v[34:35], v15 offset:2560
    s_waitcnt lgkmcnt(8)
    v_mfma_f32_32x32x16_bf16 v[84:99], v[168:171], v[40:43], v[84:99]
    ds_read_b64_tr_b16 v[36:37], v15 offset:4096
    ds_read_b64_tr_b16 v[38:39], v15 offset:4608
    s_waitcnt lgkmcnt(8)
    v_mfma_f32_32x32x16_bf16 v[84:99], v[172:175], v[20:23], v[84:99]
    ds_read_b64_tr_b16 v[40:41], v15 offset:6144
    ds_read_b64_tr_b16 v[42:43], v15 offset:6656
    s_waitcnt lgkmcnt(8)
    v_mfma_f32_32x32x16_bf16 v[84:99], v[176:179], v[24:27], v[84:99]
    ds_read_b64_tr_b16 v[20:21], v15 offset:8192
    ds_read_b64_tr_b16 v[22:23], v15 offset:8704
    s_waitcnt lgkmcnt(8)
    v_mfma_f32_32x32x16_bf16 v[84:99], v[180:183], v[28:31], v[84:99]
    ds_read_b64_tr_b16 v[24:25], v15 offset:10240
    ds_read_b64_tr_b16 v[26:27], v15 offset:10752
    s_waitcnt lgkmcnt(8)
    v_mfma_f32_32x32x16_bf16 v[84:99], v[184:187], v[32:35], v[84:99]
    ds_read_b64_tr_b16 v[28:29], v15 offset:12288
    ds_read_b64_tr_b16 v[30:31], v15 offset:12800
    s_waitcnt lgkmcnt(8)
    v_mfma_f32_32x32x16_bf16 v[84:99], v[188:191], v[36:39], v[84:99]
    ds_read_b64_tr_b16 v[32:33], v15 offset:14336
    ds_read_b64_tr_b16 v[34:35], v15 offset:14848
    s_waitcnt lgkmcnt(8)
    v_mfma_f32_32x32x16_bf16 v[84:99], v[192:195], v[40:43], v[84:99]
    ds_read_b64_tr_b16 v[36:37], v15 offset:16384
    ds_read_b64_tr_b16 v[38:39], v15 offset:16896
    s_waitcnt lgkmcnt(8)
    v_mfma_f32_32x32x16_bf16 v[84:99], v[196:199], v[20:23], v[84:99]
    ds_read_b64_tr_b16 v[40:41], v15 offset:18432
    ds_read_b64_tr_b16 v[42:43], v15 offset:18944
    s_waitcnt lgkmcnt(8)
    v_mfma_f32_32x32x16_bf16 v[84:99], v[200:203], v[24:27], v[84:99]
    ds_read_b64_tr_b16 v[20:21], v15 offset:20480
    ds_read_b64_tr_b16 v[22:23], v15 offset:20992
    s_waitcnt lgkmcnt(8)
    v_mfma_f32_32x32x16_bf16 v[84:99], v[204:207], v[28:31], v[84:99]
    ds_read_b64_tr_b16 v[24:25], v15 offset:22528
    ds_read_b64_tr_b16 v[26:27], v15 offset:23040
    s_waitcnt lgkmcnt(8)
    v_mfma_f32_32x32x16_bf16 v[84:99], v[208:211], v[32:35], v[84:99]
    ds_read_b64_tr_b16 v[28:29], v15 offset:24576
    ds_read_b64_tr_b16 v[30:31], v15 offset:25088
    s_waitcnt lgkmcnt(8)
    v_mfma_f32_32x32x16_bf16 v[84:99], v[212:215], v[36:39], v[84:99]
    ds_read_b64_tr_b16 v[32:33], v15 offset:26624
    ds_read_b64_tr_b16 v[34:35], v15 offset:27136
    s_waitcnt lgkmcnt(8)
    v_mfma_f32_32x32x16_bf16 v[84:99], v[216:219], v[40:43], v[84:99]
    ds_read_b64_tr_b16 v[36:37], v15 offset:28672
    ds_read_b64_tr_b16 v[38:39], v15 offset:29184
    s_waitcnt lgkmcnt(8)
    v_mfma_f32_32x32x16_bf16 v[84:99], v[220:223], v[20:23], v[84:99]
    ds_read_b64_tr_b16 v[40:41], v15 offset:30720
    ds_read_b64_tr_b16 v[42:43], v15 offset:31232
    s_waitcnt lgkmcnt(8)
    v_mfma_f32_32x32x16_bf16 v[84:99], v[224:227], v[24:27], v[84:99]
    s_waitcnt lgkmcnt(6)
    v_mfma_f32_32x32x16_bf16 v[84:99], v[228:231], v[28:31], v[84:99]
    s_waitcnt lgkmcnt(4)
    v_mfma_f32_32x32x16_bf16 v[84:99], v[232:235], v[32:35], v[84:99]
    s_waitcnt lgkmcnt(2)
    v_mfma_f32_32x32x16_bf16 v[84:99], v[236:239], v[36:39], v[84:99]
    s_waitcnt lgkmcnt(0)
    v_mfma_f32_32x32x16_bf16 v[84:99], v[240:243], v[40:43], v[84:99]
    ds_write_b128 v247, v[4:7]
    s_waitcnt lgkmcnt(0)
    ds_read_b64_tr_b16 v[108:109], v18 offset:0
    ds_read_b64_tr_b16 v[110:111], v18 offset:256
    ds_read_b64_tr_b16 v[112:113], v18 offset:512
    ds_read_b64_tr_b16 v[114:115], v18 offset:768
    s_setprio 2
    s_nop 2
    s_cmp_ge_u32 s68, 4
    s_cbranch_scc0 L_g4
    s_lshl_b32 s3, s22, 3
    s_add_u32 s3, s3, 19922944
    s_waitcnt vmcnt(0)
    s_mov_b64 exec, 1
    buffer_store_dwordx2 v[250:251], v252, s[44:47], s3 offen sc1
    s_mov_b64 exec, -1
    s_setprio 1
L_g4:
    s_waitcnt lgkmcnt(0)
    v_xor_b32 v108, v19, v108
    v_xor_b32 v109, v19, v109
    v_xor_b32 v110, v19, v110
    v_xor_b32 v111, v19, v111
    v_xor_b32 v112, v19, v112
    v_xor_b32 v113, v19, v113
    v_xor_b32 v114, v19, v114
    v_xor_b32 v115, v19, v115
    v_mfma_f32_32x32x16_bf16 v[20:35], v[108:111], v[68:71], 0
    s_nop 0
    v_mfma_f32_32x32x16_bf16 v[36:51], v[112:115], v[72:75], 0
    v_cvt_pk_bf16_f32 v84, v84, v85
    v_cvt_pk_bf16_f32 v85, v86, v87
    v_cvt_pk_bf16_f32 v86, v88, v89
    v_cvt_pk_bf16_f32 v87, v90, v91
    v_cvt_pk_bf16_f32 v88, v92, v93
    v_cvt_pk_bf16_f32 v89, v94, v95
    v_cvt_pk_bf16_f32 v90, v96, v97
    v_cvt_pk_bf16_f32 v91, v98, v99
    v_mov_b32 v92, 0x3f803f80
    v_mov_b32 v93, 0x3f803f80
    v_mov_b32 v94, 0x3f803f80
    v_mov_b32 v95, 0x3f803f80
    v_mov_b32 v96, 0x3f803f80
    v_mov_b32 v97, 0x3f803f80
    v_mov_b32 v98, 0x3f803f80
    v_mov_b32 v99, 0x3f803f80
    v_permlane16_swap_b32 v84, v92
    v_permlane16_swap_b32 v85, v93
    v_permlane16_swap_b32 v86, v94
    v_permlane16_swap_b32 v87, v95
    v_permlane16_swap_b32 v88, v96
    v_permlane16_swap_b32 v89, v97
    v_permlane16_swap_b32 v90, v98
    v_permlane16_swap_b32 v91, v99
    v_max3_f32 v8, v20, v21, v22
    v_max3_f32 v9, v28, v29, v30
    v_max3_f32 v8, v8, v23, v24
    v_max3_f32 v9, v9, v31, v32
    v_max3_f32 v8, v8, v25, v26
    v_max3_f32 v9, v9, v33, v34
    v_max_f32 v8, v8, v27
    v_max_f32 v9, v9, v35
    s_nop 1
    v_permlane32_swap_b32 v8, v9
    v_max_f32 v8, v8, v9
    v_mul_f32 v8, s10, v8
    v_mov_b32 v9, v8
    s_nop 1
    v_permlane32_swap_b32 v8, v9
    v_pk_fma_f32 v[20:21], v[20:21], s[10:11], v[8:9] op_sel:[0,0,0] op_sel_hi:[1,1,0] neg_lo:[0,0,1] neg_hi:[0,0,1]
    v_pk_fma_f32 v[22:23], v[22:23], s[10:11], v[8:9] op_sel:[0,0,0] op_sel_hi:[1,1,0] neg_lo:[0,0,1] neg_hi:[0,0,1]
    v_pk_fma_f32 v[24:25], v[24:25], s[10:11], v[8:9] op_sel:[0,0,0] op_sel_hi:[1,1,0] neg_lo:[0,0,1] neg_hi:[0,0,1]
    v_pk_fma_f32 v[26:27], v[26:27], s[10:11], v[8:9] op_sel:[0,0,0] op_sel_hi:[1,1,0] neg_lo:[0,0,1] neg_hi:[0,0,1]
    v_pk_fma_f32 v[28:29], v[28:29], s[10:11], v[8:9] op_sel:[0,0,1] op_sel_hi:[1,1,1] neg_lo:[0,0,1] neg_hi:[0,0,1]
    v_pk_fma_f32 v[30:31], v[30:31], s[10:11], v[8:9] op_sel:[0,0,1] op_sel_hi:[1,1,1] neg_lo:[0,0,1] neg_hi:[0,0,1]
    v_pk_fma_f32 v[32:33], v[32:33], s[10:11], v[8:9] op_sel:[0,0,1] op_sel_hi:[1,1,1] neg_lo:[0,0,1] neg_hi:[0,0,1]
    v_pk_fma_f32 v[34:35], v[34:35], s[10:11], v[8:9] op_sel:[0,0,1] op_sel_hi:[1,1,1] neg_lo:[0,0,1] neg_hi:[0,0,1]
    v_exp_f32 v20, v20
    v_exp_f32 v21, v21
    v_exp_f32 v22, v22
    v_exp_f32 v23, v23
    v_exp_f32 v24, v24
    v_exp_f32 v25, v25
    v_exp_f32 v26, v26
    v_exp_f32 v27, v27
    v_exp_f32 v28, v28
    v_exp_f32 v29, v29
    v_exp_f32 v30, v30
    v_exp_f32 v31, v31
    v_exp_f32 v32, v32
    v_exp_f32 v33, v33
    v_exp_f32 v34, v34
    v_exp_f32 v35, v35
    v_pk_add_f32 v[10:11], v[20:21], v[22:23]
    v_pk_add_f32 v[12:13], v[28:29], v[30:31]
    v_pk_add_f32 v[10:11], v[10:11], v[24:25]
    v_pk_add_f32 v[12:13], v[12:13], v[32:33]
    v_pk_add_f32 v[10:11], v[10:11], v[26:27]
    v_pk_add_f32 v[12:13], v[12:13], v[34:35]
    v_add_f32 v8, v10, v11
    v_add_f32 v9, v12, v13
    s_nop 1
    v_permlane32_swap_b32 v8, v9
    v_add_f32 v8, v8, v9
    v_rcp_f32 v8, v8
    s_nop 0
    v_mov_b32 v9, v8
    s_nop 1
    v_permlane32_swap_b32 v8, v9
    v_pk_mul_f32 v[20:21], v[20:21], v[8:9] op_sel:[0,0] op_sel_hi:[1,0]
    v_pk_mul_f32 v[22:23], v[22:23], v[8:9] op_sel:[0,0] op_sel_hi:[1,0]
    v_pk_mul_f32 v[24:25], v[24:25], v[8:9] op_sel:[0,0] op_sel_hi:[1,0]
    v_pk_mul_f32 v[26:27], v[26:27], v[8:9] op_sel:[0,0] op_sel_hi:[1,0]
    v_pk_mul_f32 v[28:29], v[28:29], v[8:9] op_sel:[0,1] op_sel_hi:[1,1]
    v_pk_mul_f32 v[30:31], v[30:31], v[8:9] op_sel:[0,1] op_sel_hi:[1,1]
    v_pk_mul_f32 v[32:33], v[32:33], v[8:9] op_sel:[0,1] op_sel_hi:[1,1]
    v_pk_mul_f32 v[34:35], v[34:35], v[8:9] op_sel:[0,1] op_sel_hi:[1,1]
    v_cvt_pk_bf16_f32 v52, v20, v21
    v_cvt_pk_bf16_f32 v53, v22, v23
    v_cvt_pk_bf16_f32 v54, v24, v25
    v_cvt_pk_bf16_f32 v55, v26, v27
    v_cvt_pk_bf16_f32 v56, v28, v29
    v_cvt_pk_bf16_f32 v57, v30, v31
    v_cvt_pk_bf16_f32 v58, v32, v33
    v_cvt_pk_bf16_f32 v59, v34, v35
    s_cmp_ge_u32 s68, 4
    s_cbranch_scc1 L_g5
    s_lshl_b32 s3, s22, 3
    s_add_u32 s3, s3, 19922944
    s_waitcnt vmcnt(0)
    s_mov_b64 exec, 1
    buffer_store_dwordx2 v[250:251], v252, s[44:47], s3 offen sc1
    s_mov_b64 exec, -1
L_g5:
    v_mfma_f32_32x32x16_bf16 v[20:35], v[52:55], v[100:103], 0
    v_mfma_f32_32x32x16_bf16 v[20:35], v[56:59], v[104:107], v[20:35]
    v_max3_f32 v8, v36, v37, v38
    v_max3_f32 v9, v44, v45, v46
    v_max3_f32 v8, v8, v39, v40
    v_max3_f32 v9, v9, v47, v48
    v_max3_f32 v8, v8, v41, v42
    v_max3_f32 v9, v9, v49, v50
    v_max_f32 v8, v8, v43
    v_max_f32 v9, v9, v51
    s_nop 1
    v_permlane32_swap_b32 v8, v9
    v_max_f32 v8, v8, v9
    v_mul_f32 v8, s10, v8
    v_mov_b32 v9, v8
    s_nop 1
    v_permlane32_swap_b32 v8, v9
    v_pk_fma_f32 v[36:37], v[36:37], s[10:11], v[8:9] op_sel:[0,0,0] op_sel_hi:[1,1,0] neg_lo:[0,0,1] neg_hi:[0,0,1]
    v_pk_fma_f32 v[38:39], v[38:39], s[10:11], v[8:9] op_sel:[0,0,0] op_sel_hi:[1,1,0] neg_lo:[0,0,1] neg_hi:[0,0,1]
    v_pk_fma_f32 v[40:41], v[40:41], s[10:11], v[8:9] op_sel:[0,0,0] op_sel_hi:[1,1,0] neg_lo:[0,0,1] neg_hi:[0,0,1]
    v_pk_fma_f32 v[42:43], v[42:43], s[10:11], v[8:9] op_sel:[0,0,0] op_sel_hi:[1,1,0] neg_lo:[0,0,1] neg_hi:[0,0,1]
    v_pk_fma_f32 v[44:45], v[44:45], s[10:11], v[8:9] op_sel:[0,0,1] op_sel_hi:[1,1,1] neg_lo:[0,0,1] neg_hi:[0,0,1]
    v_pk_fma_f32 v[46:47], v[46:47], s[10:11], v[8:9] op_sel:[0,0,1] op_sel_hi:[1,1,1] neg_lo:[0,0,1] neg_hi:[0,0,1]
    v_pk_fma_f32 v[48:49], v[48:49], s[10:11], v[8:9] op_sel:[0,0,1] op_sel_hi:[1,1,1] neg_lo:[0,0,1] neg_hi:[0,0,1]
    v_pk_fma_f32 v[50:51], v[50:51], s[10:11], v[8:9] op_sel:[0,0,1] op_sel_hi:[1,1,1] neg_lo:[0,0,1] neg_hi:[0,0,1]
    v_exp_f32 v36, v36
    v_exp_f32 v37, v37
    v_exp_f32 v38, v38
    v_exp_f32 v39, v39
    v_exp_f32 v40, v40
    v_exp_f32 v41, v41
    v_exp_f32 v42, v42
    v_exp_f32 v43, v43
    v_exp_f32 v44, v44
    v_exp_f32 v45, v45
    v_exp_f32 v46, v46
    v_exp_f32 v47, v47
    v_exp_f32 v48, v48
    v_exp_f32 v49, v49
    v_exp_f32 v50, v50
    v_exp_f32 v51, v51
    v_pk_add_f32 v[10:11], v[36:37], v[38:39]
    v_pk_add_f32 v[12:13], v[44:45], v[46:47]
    v_pk_add_f32 v[10:11], v[10:11], v[40:41]
    v_pk_add_f32 v[12:13], v[12:13], v[48:49]
    v_pk_add_f32 v[10:11], v[10:11], v[42:43]
    v_pk_add_f32 v[12:13], v[12:13], v[50:51]
    v_add_f32 v8, v10, v11
    v_add_f32 v9, v12, v13
    s_nop 1
    v_permlane32_swap_b32 v8, v9
    v_add_f32 v8, v8, v9
    v_rcp_f32 v8, v8
    s_nop 0
    v_mov_b32 v9, v8
    s_nop 1
    v_permlane32_swap_b32 v8, v9
    v_pk_mul_f32 v[36:37], v[36:37], v[8:9] op_sel:[0,0] op_sel_hi:[1,0]
    v_pk_mul_f32 v[38:39], v[38:39], v[8:9] op_sel:[0,0] op_sel_hi:[1,0]
    v_pk_mul_f32 v[40:41], v[40:41], v[8:9] op_sel:[0,0] op_sel_hi:[1,0]
    v_pk_mul_f32 v[42:43], v[42:43], v[8:9] op_sel:[0,0] op_sel_hi:[1,0]
    v_pk_mul_f32 v[44:45], v[44:45], v[8:9] op_sel:[0,1] op_sel_hi:[1,1]
    v_pk_mul_f32 v[46:47], v[46:47], v[8:9] op_sel:[0,1] op_sel_hi:[1,1]
    v_pk_mul_f32 v[48:49], v[48:49], v[8:9] op_sel:[0,1] op_sel_hi:[1,1]
    v_pk_mul_f32 v[50:51], v[50:51], v[8:9] op_sel:[0,1] op_sel_hi:[1,1]
    v_cvt_pk_bf16_f32 v60, v36, v37
    v_cvt_pk_bf16_f32 v61, v38, v39
    v_cvt_pk_bf16_f32 v62, v40, v41
    v_cvt_pk_bf16_f32 v63, v42, v43
    v_cvt_pk_bf16_f32 v64, v44, v45
    v_cvt_pk_bf16_f32 v65, v46, v47
    v_cvt_pk_bf16_f32 v66, v48, v49
    v_cvt_pk_bf16_f32 v67, v50, v51
    v_mfma_f32_32x32x16_bf16 v[36:51], v[60:63], v[100:103], 0
    s_nop 0
    v_mfma_f32_32x32x16_bf16 v[36:51], v[64:67], v[104:107], v[36:51]
    v_cvt_pk_bf16_f32 v52, v20, v21
    v_cvt_pk_bf16_f32 v53, v22, v23
    v_cvt_pk_bf16_f32 v54, v24, v25
    v_cvt_pk_bf16_f32 v55, v26, v27
    v_cvt_pk_bf16_f32 v56, v28, v29
    v_cvt_pk_bf16_f32 v57, v30, v31
    v_cvt_pk_bf16_f32 v58, v32, v33
    v_cvt_pk_bf16_f32 v59, v34, v35
    v_mfma_f32_32x32x16_bf16 v[68:83], v[52:55], v[84:87], 0
    s_nop 0
    v_mfma_f32_32x32x16_bf16 v[68:83], v[56:59], v[88:91], v[68:83]
    s_nop 0
    v_cvt_pk_bf16_f32 v60, v36, v37
    v_cvt_pk_bf16_f32 v61, v38, v39
    v_cvt_pk_bf16_f32 v62, v40, v41
    v_cvt_pk_bf16_f32 v63, v42, v43
    v_cvt_pk_bf16_f32 v64, v44, v45
    v_cvt_pk_bf16_f32 v65, v46, v47
    v_cvt_pk_bf16_f32 v66, v48, v49
    v_cvt_pk_bf16_f32 v67, v50, v51
    v_mfma_f32_32x32x16_bf16 v[20:35], v[60:63], v[92:95], 0
    s_nop 0
    v_mfma_f32_32x32x16_bf16 v[20:35], v[64:67], v[96:99], v[20:35]
    s_lshl_b32 s78, s73, 15
    s_lshl_b32 s79, s72, 12
    s_add_u32 s78, s78, s79
    s_add_u32 s78, s78, 98304
    v_add_u32 v2, s78, v17
    ds_write_b128 v2, v[68:71] offset:0
    ds_write_b128 v2, v[72:75] offset:1024
    ds_write_b128 v2, v[76:79] offset:2048
    ds_write_b128 v2, v[80:83] offset:3072
    s_nop 2
    ds_write_b128 v2, v[20:23] offset:16384
    ds_write_b128 v2, v[24:27] offset:17408
    ds_write_b128 v2, v[28:31] offset:18432
    ds_write_b128 v2, v[32:35] offset:19456
L_p1done:
    s_mul_i32 s78, s16, 2304
    s_add_u32 s78, s78, 24576
    v_add_u32 v4, s78, v17
    v_add_u32 v5, 1024, v4
    s_add_u32 s78, s78, 2048
    v_lshl_add_u32 v6, v1, 2, s78
    s_cmp_ge_u32 s68, 4
    s_cbranch_scc1 L_Y
    v_and_b32 v3, 31, v1
    v_cmp_eq_u32 s[78:79], 16, v3
    v_mov_b32 v3, 0x3f803f80
    s_nop 0
    v_cndmask_b32 v148, 0, v3, s[78:79]
    v_mov_b32 v149, v148
    v_pk_mov_b32 v[150:151], v[148:149], v[148:149]
    v_pk_mov_b32 v[152:153], v[148:149], v[148:149]
    v_pk_mov_b32 v[154:155], v[148:149], v[148:149]
    v_pk_mov_b32 v[156:157], v[148:149], v[148:149]
    v_pk_mov_b32 v[158:159], v[148:149], v[148:149]
    v_pk_mov_b32 v[160:161], v[148:149], v[148:149]
    v_pk_mov_b32 v[162:163], v[148:149], v[148:149]
    v_pk_mov_b32 v[164:165], v[148:149], v[148:149]
    v_pk_mov_b32 v[166:167], v[148:149], v[148:149]
    v_pk_mov_b32 v[168:169], v[148:149], v[148:149]
    v_pk_mov_b32 v[170:171], v[148:149], v[148:149]
    v_pk_mov_b32 v[172:173], v[148:149], v[148:149]
    v_pk_mov_b32 v[174:175], v[148:149], v[148:149]
    v_pk_mov_b32 v[176:177], v[148:149], v[148:149]
    v_pk_mov_b32 v[178:179], v[148:149], v[148:149]
    v_pk_mov_b32 v[180:181], v[148:149], v[148:149]
    v_pk_mov_b32 v[182:183], v[148:149], v[148:149]
    v_pk_mov_b32 v[184:185], v[148:149], v[148:149]
    v_pk_mov_b32 v[186:187], v[148:149], v[148:149]
    v_pk_mov_b32 v[188:189], v[148:149], v[148:149]
    v_pk_mov_b32 v[190:191], v[148:149], v[148:149]
    v_pk_mov_b32 v[192:193], v[148:149], v[148:149]
    v_pk_mov_b32 v[194:195], v[148:149], v[148:149]
    v_pk_mov_b32 v[196:197], v[148:149], v[148:149]
    v_pk_mov_b32 v[198:199], v[148:149], v[148:149]
    v_pk_mov_b32 v[200:201], v[148:149], v[148:149]
    v_pk_mov_b32 v[202:203], v[148:149], v[148:149]
    v_pk_mov_b32 v[204:205], v[148:149], v[148:149]
    v_pk_mov_b32 v[206:207], v[148:149], v[148:149]
    v_pk_mov_b32 v[208:209], v[148:149], v[148:149]
    v_pk_mov_b32 v[210:211], v[148:149], v[148:149]
    v_lshrrev_b32 v3, 1, v17
    v_xor_b32 v3, v3, v17
    v_and_b32 v3, 64, v3
    v_mul_u32_u24 v3, 3, v3
    v_xor_b32 v18, v3, v17
    v_mov_b32 v19, 0xdddddddd
    s_lshl_b32 s79, s74, 16
    s_lshl_b32 s80, s75, 13
    s_add_u32 s18, s79, s80
    s_add_u32 s18, s18, 1048576
    s_add_u32 s19, s18, 4096
    s_lshl_b32 s80, s68, 13
    s_add_u32 s79, s79, s80
    s_add_u32 s84, s79, 3145728
    s_add_u32 s86, s79, 5242880
    s_add_u32 s85, s84, 4096
    s_add_u32 s87, s86, 4096
    s_lshr_b32 s73, s16, 1
    s_lshl_b32 s78, s73, 14
    s_add_u32 s78, s78, 32768
    v_add_u32 v13, s78, v0
    s_lshl_b32 s72, s14, 5
    s_lshl_b32 s78, s73, 4
    s_add_u32 s72, s72, s78
    s_lshl_b32 s78, s72, 3
    s_add_u32 s78, s78, 36864
    v_and_b32 v2, 15, v1
    v_lshl_add_u32 v15, v2, 3, s78
    s_lshl_b32 s72, s72, 10
    s_add_u32 s72, s72, 13631488
    s_lshl_b32 s77, s14, 15
    s_add_u32 s77, s77, s15
    s_lshl_b32 s78, s73, 14
    s_add_u32 s77, s77, s78
    v_and_b32 v2, 31, v1
    v_lshlrev_b32 v14, 2, v2
    s_mul_i32 s78, s68, 4608
    v_add_u32 v8, s78, v246
    v_lshrrev_b32 v2, 2, v1
    v_and_b32 v3, 3, v1
    v_lshlrev_b32 v10, 10, v2
    v_lshl_add_u32 v10, v3, 4, v10
    s_lshl_b32 s78, s73, 4
    v_add_u32 v2, s78, v2
    v_lshlrev_b32 v16, 2, v2
    v_mul_u32_u24 v2, 144, v2
    v_lshl_add_u32 v2, v3, 5, v2
    s_and_b32 s78, s68, 5
    s_mul_i32 s78, s78, 4608
    v_add_u32 v9, s78, v2
    s_mul_i32 s78, s68, 9216
    s_add_u32 s78, s78, 24576
    v_add_u32 v11, s78, v17
    v_add_u32 v12, s78, v14
    s_lshl_b32 s17, s75, 3
    s_add_u32 s17, s17, s68
    s_lshl_b32 s23, s17, 5
    s_add_u32 s23, s23, s74
    s_lshl_b32 s22, s23, 3
    s_add_u32 s22, s22, 36864
    s_lshl_b32 s23, s23, 10
    s_add_u32 s23, s23, 13631488
    s_mov_b32 s21, 0x53800000
    s_mov_b32 s3, 19922944
    s_mov_b32 s88, 0x100000
    v_lshlrev_b32 v253, 3, v253
L_poll6:
    buffer_load_dwordx2 v[248:249], v253, s[44:47], s3 offen sc1
    s_waitcnt vmcnt(0)
    v_cmp_ne_u64 vcc, s[26:27], v[248:249]
    s_cmp_eq_u64 vcc, 0
    s_cbranch_scc1 L_polld6
    s_sub_u32 s88, s88, 1
    s_cmp_eq_u32 s88, 0
    s_cbranch_scc1 L_polld6
    s_sleep 1
    s_branch L_poll6
L_polld6:
    buffer_load_dwordx4 v[212:215], v17, s[44:47], s18 offen offset:0 sc1
    buffer_load_dwordx4 v[116:119], v18, s[44:47], s84 offen offset:0 sc1
    s_mov_b64 exec, s[4:5]
    buffer_load_dwordx4 v[148:151], v255, s[44:47], s86 offen offset:0 sc1
    buffer_load_dwordx4 v[152:155], v255, s[44:47], s86 offen offset:512 sc1
    s_mov_b64 exec, -1
    buffer_load_dwordx4 v[120:123], v18, s[44:47], s84 offen offset:1024 sc1
    s_mov_b64 exec, s[4:5]
    buffer_load_dwordx4 v[156:159], v255, s[44:47], s86 offen offset:1024 sc1
    buffer_load_dwordx4 v[160:163], v255, s[44:47], s86 offen offset:1536 sc1
    s_mov_b64 exec, -1
    buffer_load_dwordx4 v[124:127], v18, s[44:47], s84 offen offset:2048 sc1
    s_mov_b64 exec, s[4:5]
    buffer_load_dwordx4 v[164:167], v255, s[44:47], s86 offen offset:2048 sc1
    buffer_load_dwordx4 v[168:171], v255, s[44:47], s86 offen offset:2560 sc1
    s_mov_b64 exec, -1
    buffer_load_dwordx4 v[128:131], v18, s[44:47], s84 offen offset:3072 sc1
    s_mov_b64 exec, s[4:5]
    buffer_load_dwordx4 v[172:175], v255, s[44:47], s86 offen offset:3072 sc1
    buffer_load_dwordx4 v[176:179], v255, s[44:47], s86 offen offset:3584 sc1
    s_mov_b64 exec, -1
    buffer_load_dwordx4 v[132:135], v18, s[44:47], s85 offen offset:0 sc1
    s_waitcnt lgkmcnt(0)
    v_pk_mov_b32 v[52:53], 0, 0
    v_pk_mov_b32 v[54:55], 0, 0
    v_pk_mov_b32 v[56:57], 0, 0
    v_pk_mov_b32 v[58:59], 0, 0
    v_pk_mov_b32 v[60:61], 0, 0
    v_pk_mov_b32 v[62:63], 0, 0
    v_pk_mov_b32 v[64:65], 0, 0
    v_pk_mov_b32 v[66:67], 0, 0
    v_pk_mov_b32 v[68:69], 0, 0
    v_pk_mov_b32 v[70:71], 0, 0
    v_pk_mov_b32 v[72:73], 0, 0
    v_pk_mov_b32 v[74:75], 0, 0
    v_pk_mov_b32 v[76:77], 0, 0
    v_pk_mov_b32 v[78:79], 0, 0
    v_pk_mov_b32 v[80:81], 0, 0
    v_pk_mov_b32 v[82:83], 0, 0
    v_pk_mov_b32 v[84:85], 0, 0
    v_pk_mov_b32 v[86:87], 0, 0
    v_pk_mov_b32 v[88:89], 0, 0
    v_pk_mov_b32 v[90:91], 0, 0
    v_pk_mov_b32 v[92:93], 0, 0
    v_pk_mov_b32 v[94:95], 0, 0
    v_pk_mov_b32 v[96:97], 0, 0
    v_pk_mov_b32 v[98:99], 0, 0
    v_pk_mov_b32 v[100:101], 0, 0
    v_pk_mov_b32 v[102:103], 0, 0
    v_pk_mov_b32 v[104:105], 0, 0
    v_pk_mov_b32 v[106:107], 0, 0
    v_pk_mov_b32 v[108:109], 0, 0
    v_pk_mov_b32 v[110:111], 0, 0
    s_waitcnt vmcnt(12)
    s_setprio 0
    v_mfma_f32_32x32x16_bf16 v[20:35], v[116:119], v[212:215], 0
    .p2align 3
    s_nop 11
    v_exp_f32 v20, v20
    v_exp_f32 v21, v21
    v_exp_f32 v22, v22
    v_exp_f32 v23, v23
    v_exp_f32 v24, v24
    s_waitcnt vmcnt(9)
    v_mfma_f32_32x32x16_bf16 v[36:51], v[120:123], v[212:215], 0
    s_mov_b64 exec, s[4:5]
    buffer_load_dwordx4 v[180:183], v255, s[44:47], s87 offen offset:0 sc1
    buffer_load_dwordx4 v[184:187], v255, s[44:47], s87 offen offset:512 sc1
    s_mov_b64 exec, -1
    buffer_load_dwordx4 v[136:139], v18, s[44:47], s85 offen offset:1024 sc1
    v_exp_f32 v25, v25
    v_exp_f32 v26, v26
    v_exp_f32 v27, v27
    v_exp_f32 v28, v28
    v_exp_f32 v29, v29
    v_exp_f32 v30, v30
    v_smfmac_f32_32x32x32_bf16 v[52:67], v[148:151], v[20:27], v19
    v_exp_f32 v31, v31
    v_exp_f32 v32, v32
    v_exp_f32 v33, v33
    v_exp_f32 v34, v34
    v_exp_f32 v35, v35
    v_exp_f32 v36, v36
    v_exp_f32 v37, v37
    v_smfmac_f32_32x32x32_bf16 v[52:67], v[152:155], v[28:35], v19
    v_exp_f32 v38, v38
    v_exp_f32 v39, v39
    v_exp_f32 v40, v40
    s_waitcnt vmcnt(9)
    v_mfma_f32_32x32x16_bf16 v[20:35], v[124:127], v[212:215], 0
    s_mov_b64 exec, s[4:5]
    buffer_load_dwordx4 v[188:191], v255, s[44:47], s87 offen offset:1024 sc1
    buffer_load_dwordx4 v[192:195], v255, s[44:47], s87 offen offset:1536 sc1
    s_mov_b64 exec, -1
    buffer_load_dwordx4 v[140:143], v18, s[44:47], s85 offen offset:2048 sc1
    v_exp_f32 v41, v41
    v_exp_f32 v42, v42
    v_exp_f32 v43, v43
    v_exp_f32 v44, v44
    v_exp_f32 v45, v45
    v_exp_f32 v46, v46
    v_smfmac_f32_32x32x32_bf16 v[52:67], v[156:159], v[36:43], v19
    v_exp_f32 v47, v47
    v_exp_f32 v48, v48
    v_exp_f32 v49, v49
    v_exp_f32 v50, v50
    v_exp_f32 v51, v51
    v_exp_f32 v20, v20
    v_exp_f32 v21, v21
    v_smfmac_f32_32x32x32_bf16 v[52:67], v[160:163], v[44:51], v19
    v_exp_f32 v22, v22
    v_exp_f32 v23, v23
    v_exp_f32 v24, v24
    s_waitcnt vmcnt(9)
    v_mfma_f32_32x32x16_bf16 v[36:51], v[128:131], v[212:215], 0
    s_mov_b64 exec, s[4:5]
    buffer_load_dwordx4 v[196:199], v255, s[44:47], s87 offen offset:2048 sc1
    buffer_load_dwordx4 v[200:203], v255, s[44:47], s87 offen offset:2560 sc1
    s_mov_b64 exec, -1
    buffer_load_dwordx4 v[144:147], v18, s[44:47], s85 offen offset:3072 sc1
    v_exp_f32 v25, v25
    v_exp_f32 v26, v26
    v_exp_f32 v27, v27
    v_exp_f32 v28, v28
    v_exp_f32 v29, v29
    v_exp_f32 v30, v30
    v_smfmac_f32_32x32x32_bf16 v[52:67], v[164:167], v[20:27], v19
    v_exp_f32 v31, v31
    v_exp_f32 v32, v32
    v_exp_f32 v33, v33
    v_exp_f32 v34, v34
    v_exp_f32 v35, v35
    v_exp_f32 v36, v36
    v_exp_f32 v37, v37
    v_smfmac_f32_32x32x32_bf16 v[52:67], v[168:171], v[28:35], v19
    v_exp_f32 v38, v38
    v_exp_f32 v39, v39
    v_exp_f32 v40, v40
    s_waitcnt vmcnt(9)
    v_mfma_f32_32x32x16_bf16 v[20:35], v[132:135], v[212:215], 0
    s_mov_b64 exec, s[4:5]
    buffer_load_dwordx4 v[204:207], v255, s[44:47], s87 offen offset:3072 sc1
    buffer_load_dwordx4 v[208:211], v255, s[44:47], s87 offen offset:3584 sc1
    s_mov_b64 exec, -1
    buffer_load_dwordx4 v[216:219], v17, s[44:47], s18 offen offset:1024 sc1
    v_exp_f32 v41, v41
    v_exp_f32 v42, v42
    v_exp_f32 v43, v43
    v_exp_f32 v44, v44
    v_exp_f32 v45, v45
    v_exp_f32 v46, v46
    v_smfmac_f32_32x32x32_bf16 v[52:67], v[172:175], v[36:43], v19
    v_exp_f32 v47, v47
    v_exp_f32 v48, v48
    v_exp_f32 v49, v49
    v_exp_f32 v50, v50
    v_exp_f32 v51, v51
    v_exp_f32 v20, v20
    v_exp_f32 v21, v21
    v_smfmac_f32_32x32x32_bf16 v[52:67], v[176:179], v[44:51], v19
    v_exp_f32 v22, v22
    v_exp_f32 v23, v23
    v_exp_f32 v24, v24
    s_waitcnt vmcnt(9)
    v_mfma_f32_32x32x16_bf16 v[36:51], v[136:139], v[212:215], 0
    buffer_load_dwordx4 v[220:223], v17, s[44:47], s18 offen offset:2048 sc1
    buffer_load_dwordx4 v[224:227], v17, s[44:47], s18 offen offset:3072 sc1
    buffer_load_dwordx4 v[228:231], v17, s[44:47], s19 offen offset:0 sc1
    v_exp_f32 v25, v25
    v_exp_f32 v26, v26
    v_exp_f32 v27, v27
    v_exp_f32 v28, v28
    v_exp_f32 v29, v29
    v_exp_f32 v30, v30
    v_smfmac_f32_32x32x32_bf16 v[52:67], v[180:183], v[20:27], v19
    v_exp_f32 v31, v31
    v_exp_f32 v32, v32
    v_exp_f32 v33, v33
    v_exp_f32 v34, v34
    v_exp_f32 v35, v35
    v_exp_f32 v36, v36
    v_exp_f32 v37, v37
    v_smfmac_f32_32x32x32_bf16 v[52:67], v[184:187], v[28:35], v19
    v_exp_f32 v38, v38
    v_exp_f32 v39, v39
    v_exp_f32 v40, v40
    s_waitcnt vmcnt(9)
    v_mfma_f32_32x32x16_bf16 v[20:35], v[140:143], v[212:215], 0
    buffer_load_dwordx4 v[232:235], v17, s[44:47], s19 offen offset:1024 sc1
    buffer_load_dwordx4 v[236:239], v17, s[44:47], s19 offen offset:2048 sc1
    buffer_load_dwordx4 v[240:243], v17, s[44:47], s19 offen offset:3072 sc1
    v_exp_f32 v41, v41
    v_exp_f32 v42, v42
    v_exp_f32 v43, v43
    v_exp_f32 v44, v44
    v_exp_f32 v45, v45
    v_exp_f32 v46, v46
    v_smfmac_f32_32x32x32_bf16 v[52:67], v[188:191], v[36:43], v19
    v_exp_f32 v47, v47
    v_exp_f32 v48, v48
    v_exp_f32 v49, v49
    v_exp_f32 v50, v50
    v_exp_f32 v51, v51
    v_exp_f32 v20, v20
    v_exp_f32 v21, v21
    v_smfmac_f32_32x32x32_bf16 v[52:67], v[192:195], v[44:51], v19
    v_exp_f32 v22, v22
    v_exp_f32 v23, v23
    v_exp_f32 v24, v24
    s_waitcnt vmcnt(9)
    v_mfma_f32_32x32x16_bf16 v[36:51], v[144:147], v[212:215], 0
    v_exp_f32 v25, v25
    v_exp_f32 v26, v26
    v_exp_f32 v27, v27
    v_exp_f32 v28, v28
    v_exp_f32 v29, v29
    v_exp_f32 v30, v30
    v_smfmac_f32_32x32x32_bf16 v[52:67], v[196:199], v[20:27], v19
    v_exp_f32 v31, v31
    v_exp_f32 v32, v32
    v_exp_f32 v33, v33
    v_exp_f32 v34, v34
    v_exp_f32 v35, v35
    v_exp_f32 v36, v36
    v_exp_f32 v37, v37
    v_smfmac_f32_32x32x32_bf16 v[52:67], v[200:203], v[28:35], v19
    s_waitcnt lgkmcnt(0)
    s_barrier
    v_exp_f32 v38, v38
    v_exp_f32 v39, v39
    v_exp_f32 v40, v40
    s_waitcnt vmcnt(6)
    v_mfma_f32_32x32x16_bf16 v[20:35], v[116:119], v[216:219], 0
    v_exp_f32 v41, v41
    v_exp_f32 v42, v42
    v_exp_f32 v43, v43
    v_exp_f32 v44, v44
    v_exp_f32 v45, v45
    v_exp_f32 v46, v46
    v_smfmac_f32_32x32x32_bf16 v[52:67], v[204:207], v[36:43], v19
    v_exp_f32 v47, v47
    v_exp_f32 v48, v48
    v_exp_f32 v49, v49
    v_exp_f32 v50, v50
    v_exp_f32 v51, v51
    v_exp_f32 v20, v20
    v_exp_f32 v21, v21
    v_smfmac_f32_32x32x32_bf16 v[52:67], v[208:211], v[44:51], v19
    v_exp_f32 v22, v22
    v_exp_f32 v23, v23
    v_exp_f32 v24, v24
    v_mfma_f32_32x32x16_bf16 v[36:51], v[120:123], v[216:219], 0
    v_exp_f32 v25, v25
    v_exp_f32 v26, v26
    v_exp_f32 v27, v27
    v_exp_f32 v28, v28
    v_exp_f32 v29, v29
    v_exp_f32 v30, v30
    v_smfmac_f32_32x32x32_bf16 v[62:77], v[148:151], v[20:27], v19
    v_exp_f32 v31, v31
    v_exp_f32 v32, v32
    v_exp_f32 v33, v33
    v_exp_f32 v34, v34
    v_exp_f32 v35, v35
    v_exp_f32 v36, v36
    v_exp_f32 v37, v37
    v_smfmac_f32_32x32x32_bf16 v[62:77], v[152:155], v[28:35], v19
    v_exp_f32 v38, v38
    v_exp_f32 v39, v39
    v_exp_f32 v40, v40
    v_mfma_f32_32x32x16_bf16 v[20:35], v[124:127], v[216:219], 0
    v_exp_f32 v41, v41
    v_exp_f32 v42, v42
    v_exp_f32 v43, v43
    v_exp_f32 v44, v44
    v_exp_f32 v45, v45
    v_exp_f32 v46, v46
    v_smfmac_f32_32x32x32_bf16 v[62:77], v[156:159], v[36:43], v19
    ds_write_b128 v4, v[52:55] offset:0
    v_exp_f32 v47, v47
    v_exp_f32 v48, v48
    v_exp_f32 v49, v49
    v_exp_f32 v50, v50
    v_exp_f32 v51, v51
    v_exp_f32 v20, v20
    v_exp_f32 v21, v21
    v_smfmac_f32_32x32x32_bf16 v[62:77], v[160:163], v[44:51], v19
    v_exp_f32 v22, v22
    v_exp_f32 v23, v23
    v_exp_f32 v24, v24
    v_mfma_f32_32x32x16_bf16 v[36:51], v[128:131], v[216:219], 0
    v_exp_f32 v25, v25
    v_exp_f32 v26, v26
    v_exp_f32 v27, v27
    v_exp_f32 v28, v28
    v_exp_f32 v29, v29
    v_exp_f32 v30, v30
    v_smfmac_f32_32x32x32_bf16 v[62:77], v[164:167], v[20:27], v19
    ds_write_b128 v5, v[56:59] offset:0
    v_exp_f32 v31, v31
    v_exp_f32 v32, v32
    v_exp_f32 v33, v33
    v_exp_f32 v34, v34
    v_exp_f32 v35, v35
    v_exp_f32 v36, v36
    v_exp_f32 v37, v37
    v_smfmac_f32_32x32x32_bf16 v[62:77], v[168:171], v[28:35], v19
    v_exp_f32 v38, v38
    v_exp_f32 v39, v39
    v_exp_f32 v40, v40
    v_mfma_f32_32x32x16_bf16 v[20:35], v[132:135], v[216:219], 0
    v_exp_f32 v41, v41
    v_exp_f32 v42, v42
    v_exp_f32 v43, v43
    v_exp_f32 v44, v44
    v_exp_f32 v45, v45
    v_exp_f32 v46, v46
    v_smfmac_f32_32x32x32_bf16 v[62:77], v[172:175], v[36:43], v19
    ds_write_b32 v6, v60 offset:0
    v_exp_f32 v47, v47
    v_exp_f32 v48, v48
    v_exp_f32 v49, v49
    v_exp_f32 v50, v50
    v_exp_f32 v51, v51
    v_exp_f32 v20, v20
    v_exp_f32 v21, v21
    v_smfmac_f32_32x32x32_bf16 v[62:77], v[176:179], v[44:51], v19
    v_exp_f32 v22, v22
    v_exp_f32 v23, v23
    v_exp_f32 v24, v24
    v_mfma_f32_32x32x16_bf16 v[36:51], v[136:139], v[216:219], 0
    v_exp_f32 v25, v25
    v_exp_f32 v26, v26
    v_exp_f32 v27, v27
    v_exp_f32 v28, v28
    v_exp_f32 v29, v29
    v_exp_f32 v30, v30
    v_smfmac_f32_32x32x32_bf16 v[62:77], v[180:183], v[20:27], v19
    v_exp_f32 v31, v31
    v_exp_f32 v32, v32
    v_exp_f32 v33, v33
    v_exp_f32 v34, v34
    v_exp_f32 v35, v35
    v_exp_f32 v36, v36
    v_exp_f32 v37, v37
    v_smfmac_f32_32x32x32_bf16 v[62:77], v[184:187], v[28:35], v19
    v_exp_f32 v38, v38
    v_exp_f32 v39, v39
    v_exp_f32 v40, v40
    v_mfma_f32_32x32x16_bf16 v[20:35], v[140:143], v[216:219], 0
    v_exp_f32 v41, v41
    v_exp_f32 v42, v42
    v_exp_f32 v43, v43
    v_exp_f32 v44, v44
    v_exp_f32 v45, v45
    v_exp_f32 v46, v46
    v_smfmac_f32_32x32x32_bf16 v[62:77], v[188:191], v[36:43], v19
    v_exp_f32 v47, v47
    v_exp_f32 v48, v48
    v_exp_f32 v49, v49
    v_exp_f32 v50, v50
    v_exp_f32 v51, v51
    v_exp_f32 v20, v20
    v_exp_f32 v21, v21
    v_smfmac_f32_32x32x32_bf16 v[62:77], v[192:195], v[44:51], v19
    v_exp_f32 v22, v22
    v_exp_f32 v23, v23
    v_exp_f32 v24, v24
    v_mfma_f32_32x32x16_bf16 v[36:51], v[144:147], v[216:219], 0
    v_exp_f32 v25, v25
    v_exp_f32 v26, v26
    v_exp_f32 v27, v27
    v_exp_f32 v28, v28
    v_exp_f32 v29, v29
    v_exp_f32 v30, v30
    v_smfmac_f32_32x32x32_bf16 v[62:77], v[196:199], v[20:27], v19
    v_exp_f32 v31, v31
    v_exp_f32 v32, v32
    v_exp_f32 v33, v33
    v_exp_f32 v34, v34
    v_exp_f32 v35, v35
    v_exp_f32 v36, v36
    v_exp_f32 v37, v37
    v_smfmac_f32_32x32x32_bf16 v[62:77], v[200:203], v[28:35], v19
    v_exp_f32 v38, v38
    v_exp_f32 v39, v39
    v_exp_f32 v40, v40
    s_waitcnt vmcnt(0)
    v_mfma_f32_32x32x16_bf16 v[20:35], v[116:119], v[220:223], 0
    v_exp_f32 v41, v41
    v_exp_f32 v42, v42
    v_exp_f32 v43, v43
    v_exp_f32 v44, v44
    v_exp_f32 v45, v45
    v_exp_f32 v46, v46
    v_smfmac_f32_32x32x32_bf16 v[62:77], v[204:207], v[36:43], v19
    v_exp_f32 v47, v47
    v_exp_f32 v48, v48
    v_exp_f32 v49, v49
    v_exp_f32 v50, v50
    v_exp_f32 v51, v51
    v_exp_f32 v20, v20
    v_exp_f32 v21, v21
    v_smfmac_f32_32x32x32_bf16 v[62:77], v[208:211], v[44:51], v19
    v_exp_f32 v22, v22
    v_exp_f32 v23, v23
    v_exp_f32 v24, v24
    v_mfma_f32_32x32x16_bf16 v[36:51], v[120:123], v[220:223], 0
    v_exp_f32 v25, v25
    v_exp_f32 v26, v26
    v_exp_f32 v27, v27
    v_exp_f32 v28, v28
    v_exp_f32 v29, v29
    v_exp_f32 v30, v30
    v_smfmac_f32_32x32x32_bf16 v[72:87], v[148:151], v[20:27], v19
    v_exp_f32 v31, v31
    v_exp_f32 v32, v32
    v_exp_f32 v33, v33
    v_exp_f32 v34, v34
    v_exp_f32 v35, v35
    v_exp_f32 v36, v36
    v_exp_f32 v37, v37
    v_smfmac_f32_32x32x32_bf16 v[72:87], v[152:155], v[28:35], v19
    v_exp_f32 v38, v38
    v_exp_f32 v39, v39
    v_exp_f32 v40, v40
    v_mfma_f32_32x32x16_bf16 v[20:35], v[124:127], v[220:223], 0
    v_exp_f32 v41, v41
    v_exp_f32 v42, v42
    v_exp_f32 v43, v43
    v_exp_f32 v44, v44
    v_exp_f32 v45, v45
    v_exp_f32 v46, v46
    v_smfmac_f32_32x32x32_bf16 v[72:87], v[156:159], v[36:43], v19
    ds_write_b128 v4, v[62:65] offset:9216
    v_exp_f32 v47, v47
    v_exp_f32 v48, v48
    v_exp_f32 v49, v49
    v_exp_f32 v50, v50
    v_exp_f32 v51, v51
    v_exp_f32 v20, v20
    v_exp_f32 v21, v21
    v_smfmac_f32_32x32x32_bf16 v[72:87], v[160:163], v[44:51], v19
    v_exp_f32 v22, v22
    v_exp_f32 v23, v23
    v_exp_f32 v24, v24
    v_mfma_f32_32x32x16_bf16 v[36:51], v[128:131], v[220:223], 0
    v_exp_f32 v25, v25
    v_exp_f32 v26, v26
    v_exp_f32 v27, v27
    v_exp_f32 v28, v28
    v_exp_f32 v29, v29
    v_exp_f32 v30, v30
    v_smfmac_f32_32x32x32_bf16 v[72:87], v[164:167], v[20:27], v19
    ds_write_b128 v5, v[66:69] offset:9216
    v_exp_f32 v31, v31
    v_exp_f32 v32, v32
    v_exp_f32 v33, v33
    v_exp_f32 v34, v34
    v_exp_f32 v35, v35
    v_exp_f32 v36, v36
    v_exp_f32 v37, v37
    v_smfmac_f32_32x32x32_bf16 v[72:87], v[168:171], v[28:35], v19
    v_exp_f32 v38, v38
    v_exp_f32 v39, v39
    v_exp_f32 v40, v40
    v_mfma_f32_32x32x16_bf16 v[20:35], v[132:135], v[220:223], 0
    v_exp_f32 v41, v41
    v_exp_f32 v42, v42
    v_exp_f32 v43, v43
    v_exp_f32 v44, v44
    v_exp_f32 v45, v45
    v_exp_f32 v46, v46
    v_smfmac_f32_32x32x32_bf16 v[72:87], v[172:175], v[36:43], v19
    ds_write_b32 v6, v70 offset:9216
    v_exp_f32 v47, v47
    v_exp_f32 v48, v48
    v_exp_f32 v49, v49
    v_exp_f32 v50, v50
    v_exp_f32 v51, v51
    v_exp_f32 v20, v20
    v_exp_f32 v21, v21
    v_smfmac_f32_32x32x32_bf16 v[72:87], v[176:179], v[44:51], v19
    v_exp_f32 v22, v22
    v_exp_f32 v23, v23
    v_exp_f32 v24, v24
    v_mfma_f32_32x32x16_bf16 v[36:51], v[136:139], v[220:223], 0
    v_exp_f32 v25, v25
    v_exp_f32 v26, v26
    v_exp_f32 v27, v27
    v_exp_f32 v28, v28
    v_exp_f32 v29, v29
    v_exp_f32 v30, v30
    v_smfmac_f32_32x32x32_bf16 v[72:87], v[180:183], v[20:27], v19
    v_exp_f32 v31, v31
    v_exp_f32 v32, v32
    v_exp_f32 v33, v33
    v_exp_f32 v34, v34
    v_exp_f32 v35, v35
    v_exp_f32 v36, v36
    v_exp_f32 v37, v37
    v_smfmac_f32_32x32x32_bf16 v[72:87], v[184:187], v[28:35], v19
    v_exp_f32 v38, v38
    v_exp_f32 v39, v39
    v_exp_f32 v40, v40
    v_mfma_f32_32x32x16_bf16 v[20:35], v[140:143], v[220:223], 0
    v_exp_f32 v41, v41
    v_exp_f32 v42, v42
    v_exp_f32 v43, v43
    v_exp_f32 v44, v44
    v_exp_f32 v45, v45
    v_exp_f32 v46, v46
    v_smfmac_f32_32x32x32_bf16 v[72:87], v[188:191], v[36:43], v19
    v_exp_f32 v47, v47
    v_exp_f32 v48, v48
    v_exp_f32 v49, v49
    v_exp_f32 v50, v50
    v_exp_f32 v51, v51
    v_exp_f32 v20, v20
    v_exp_f32 v21, v21
    v_smfmac_f32_32x32x32_bf16 v[72:87], v[192:195], v[44:51], v19
    v_exp_f32 v22, v22
    v_exp_f32 v23, v23
    v_exp_f32 v24, v24
    v_mfma_f32_32x32x16_bf16 v[36:51], v[144:147], v[220:223], 0
    v_exp_f32 v25, v25
    v_exp_f32 v26, v26
    v_exp_f32 v27, v27
    v_exp_f32 v28, v28
    v_exp_f32 v29, v29
    v_exp_f32 v30, v30
    v_smfmac_f32_32x32x32_bf16 v[72:87], v[196:199], v[20:27], v19
    v_exp_f32 v31, v31
    v_exp_f32 v32, v32
    v_exp_f32 v33, v33
    v_exp_f32 v34, v34
    v_exp_f32 v35, v35
    v_exp_f32 v36, v36
    v_exp_f32 v37, v37
    v_smfmac_f32_32x32x32_bf16 v[72:87], v[200:203], v[28:35], v19
    v_exp_f32 v38, v38
    v_exp_f32 v39, v39
    v_exp_f32 v40, v40
    v_mfma_f32_32x32x16_bf16 v[20:35], v[116:119], v[224:227], 0
    v_exp_f32 v41, v41
    v_exp_f32 v42, v42
    v_exp_f32 v43, v43
    v_exp_f32 v44, v44
    v_exp_f32 v45, v45
    v_exp_f32 v46, v46
    v_smfmac_f32_32x32x32_bf16 v[72:87], v[204:207], v[36:43], v19
    v_exp_f32 v47, v47
    v_exp_f32 v48, v48
    v_exp_f32 v49, v49
    v_exp_f32 v50, v50
    v_exp_f32 v51, v51
    v_exp_f32 v20, v20
    v_exp_f32 v21, v21
    v_smfmac_f32_32x32x32_bf16 v[72:87], v[208:211], v[44:51], v19
    v_exp_f32 v22, v22
    v_exp_f32 v23, v23
    v_exp_f32 v24, v24
    v_mfma_f32_32x32x16_bf16 v[36:51], v[120:123], v[224:227], 0
    v_exp_f32 v25, v25
    v_exp_f32 v26, v26
    v_exp_f32 v27, v27
    v_exp_f32 v28, v28
    v_exp_f32 v29, v29
    v_exp_f32 v30, v30
    v_smfmac_f32_32x32x32_bf16 v[82:97], v[148:151], v[20:27], v19
    v_exp_f32 v31, v31
    v_exp_f32 v32, v32
    v_exp_f32 v33, v33
    v_exp_f32 v34, v34
    v_exp_f32 v35, v35
    v_exp_f32 v36, v36
    v_exp_f32 v37, v37
    v_smfmac_f32_32x32x32_bf16 v[82:97], v[152:155], v[28:35], v19
    v_exp_f32 v38, v38
    v_exp_f32 v39, v39
    v_exp_f32 v40, v40
    v_mfma_f32_32x32x16_bf16 v[20:35], v[124:127], v[224:227], 0
    v_exp_f32 v41, v41
    v_exp_f32 v42, v42
    v_exp_f32 v43, v43
    v_exp_f32 v44, v44
    v_exp_f32 v45, v45
    v_exp_f32 v46, v46
    v_smfmac_f32_32x32x32_bf16 v[82:97], v[156:159], v[36:43], v19
    ds_write_b128 v4, v[72:75] offset:18432
    v_exp_f32 v47, v47
    v_exp_f32 v48, v48
    v_exp_f32 v49, v49
    v_exp_f32 v50, v50
    v_exp_f32 v51, v51
    v_exp_f32 v20, v20
    v_exp_f32 v21, v21
    v_smfmac_f32_32x32x32_bf16 v[82:97], v[160:163], v[44:51], v19
    v_exp_f32 v22, v22
    v_exp_f32 v23, v23
    v_exp_f32 v24, v24
    v_mfma_f32_32x32x16_bf16 v[36:51], v[128:131], v[224:227], 0
    v_exp_f32 v25, v25
    v_exp_f32 v26, v26
    v_exp_f32 v27, v27
    v_exp_f32 v28, v28
    v_exp_f32 v29, v29
    v_exp_f32 v30, v30
    v_smfmac_f32_32x32x32_bf16 v[82:97], v[164:167], v[20:27], v19
    ds_write_b128 v5, v[76:79] offset:18432
    v_exp_f32 v31, v31
    v_exp_f32 v32, v32
    v_exp_f32 v33, v33
    v_exp_f32 v34, v34
    v_exp_f32 v35, v35
    v_exp_f32 v36, v36
    v_exp_f32 v37, v37
    v_smfmac_f32_32x32x32_bf16 v[82:97], v[168:171], v[28:35], v19
    v_exp_f32 v38, v38
    v_exp_f32 v39, v39
    v_exp_f32 v40, v40
    v_mfma_f32_32x32x16_bf16 v[20:35], v[132:135], v[224:227], 0
    v_exp_f32 v41, v41
    v_exp_f32 v42, v42
    v_exp_f32 v43, v43
    v_exp_f32 v44, v44
    v_exp_f32 v45, v45
    v_exp_f32 v46, v46
    v_smfmac_f32_32x32x32_bf16 v[82:97], v[172:175], v[36:43], v19
    ds_write_b32 v6, v80 offset:18432
    v_exp_f32 v47, v47
    v_exp_f32 v48, v48
    v_exp_f32 v49, v49
    v_exp_f32 v50, v50
    v_exp_f32 v51, v51
    v_exp_f32 v20, v20
    v_exp_f32 v21, v21
    v_smfmac_f32_32x32x32_bf16 v[82:97], v[176:179], v[44:51], v19
    v_exp_f32 v22, v22
    v_exp_f32 v23, v23
    v_exp_f32 v24, v24
    v_mfma_f32_32x32x16_bf16 v[36:51], v[136:139], v[224:227], 0
    v_exp_f32 v25, v25
    v_exp_f32 v26, v26
    v_exp_f32 v27, v27
    v_exp_f32 v28, v28
    v_exp_f32 v29, v29
    v_exp_f32 v30, v30
    v_smfmac_f32_32x32x32_bf16 v[82:97], v[180:183], v[20:27], v19
    v_exp_f32 v31, v31
    v_exp_f32 v32, v32
    v_exp_f32 v33, v33
    v_exp_f32 v34, v34
    v_exp_f32 v35, v35
    v_exp_f32 v36, v36
    v_exp_f32 v37, v37
    v_smfmac_f32_32x32x32_bf16 v[82:97], v[184:187], v[28:35], v19
    v_exp_f32 v38, v38
    v_exp_f32 v39, v39
    v_exp_f32 v40, v40
    v_mfma_f32_32x32x16_bf16 v[20:35], v[140:143], v[224:227], 0
    v_exp_f32 v41, v41
    v_exp_f32 v42, v42
    v_exp_f32 v43, v43
    v_exp_f32 v44, v44
    v_exp_f32 v45, v45
    v_exp_f32 v46, v46
    v_smfmac_f32_32x32x32_bf16 v[82:97], v[188:191], v[36:43], v19
    v_exp_f32 v47, v47
    v_exp_f32 v48, v48
    v_exp_f32 v49, v49
    v_exp_f32 v50, v50
    v_exp_f32 v51, v51
    v_exp_f32 v20, v20
    v_exp_f32 v21, v21
    v_smfmac_f32_32x32x32_bf16 v[82:97], v[192:195], v[44:51], v19
    v_exp_f32 v22, v22
    v_exp_f32 v23, v23
    v_exp_f32 v24, v24
    v_mfma_f32_32x32x16_bf16 v[36:51], v[144:147], v[224:227], 0
    v_exp_f32 v25, v25
    v_exp_f32 v26, v26
    v_exp_f32 v27, v27
    v_exp_f32 v28, v28
    v_exp_f32 v29, v29
    v_exp_f32 v30, v30
    v_smfmac_f32_32x32x32_bf16 v[82:97], v[196:199], v[20:27], v19
    v_exp_f32 v31, v31
    v_exp_f32 v32, v32
    v_exp_f32 v33, v33
    v_exp_f32 v34, v34
    v_exp_f32 v35, v35
    v_exp_f32 v36, v36
    v_exp_f32 v37, v37
    v_smfmac_f32_32x32x32_bf16 v[82:97], v[200:203], v[28:35], v19
    v_exp_f32 v38, v38
    v_exp_f32 v39, v39
    v_exp_f32 v40, v40
    v_mfma_f32_32x32x16_bf16 v[20:35], v[116:119], v[228:231], 0
    v_exp_f32 v41, v41
    v_exp_f32 v42, v42
    v_exp_f32 v43, v43
    v_exp_f32 v44, v44
    v_exp_f32 v45, v45
    v_exp_f32 v46, v46
    v_smfmac_f32_32x32x32_bf16 v[82:97], v[204:207], v[36:43], v19
    v_exp_f32 v47, v47
    v_exp_f32 v48, v48
    v_exp_f32 v49, v49
    v_exp_f32 v50, v50
    v_exp_f32 v51, v51
    v_exp_f32 v20, v20
    v_exp_f32 v21, v21
    v_smfmac_f32_32x32x32_bf16 v[82:97], v[208:211], v[44:51], v19
    v_exp_f32 v22, v22
    v_exp_f32 v23, v23
    v_exp_f32 v24, v24
    v_mfma_f32_32x32x16_bf16 v[36:51], v[120:123], v[228:231], 0
    v_exp_f32 v25, v25
    v_exp_f32 v26, v26
    v_exp_f32 v27, v27
    v_exp_f32 v28, v28
    v_exp_f32 v29, v29
    v_exp_f32 v30, v30
    v_smfmac_f32_32x32x32_bf16 v[92:107], v[148:151], v[20:27], v19
    v_exp_f32 v31, v31
    v_exp_f32 v32, v32
    v_exp_f32 v33, v33
    v_exp_f32 v34, v34
    v_exp_f32 v35, v35
    v_exp_f32 v36, v36
    v_exp_f32 v37, v37
    v_smfmac_f32_32x32x32_bf16 v[92:107], v[152:155], v[28:35], v19
    v_exp_f32 v38, v38
    v_exp_f32 v39, v39
    v_exp_f32 v40, v40
    v_mfma_f32_32x32x16_bf16 v[20:35], v[124:127], v[228:231], 0
    v_exp_f32 v41, v41
    v_exp_f32 v42, v42
    v_exp_f32 v43, v43
    v_exp_f32 v44, v44
    v_exp_f32 v45, v45
    v_exp_f32 v46, v46
    v_smfmac_f32_32x32x32_bf16 v[92:107], v[156:159], v[36:43], v19
    ds_write_b128 v4, v[82:85] offset:27648
    v_exp_f32 v47, v47
    v_exp_f32 v48, v48
    v_exp_f32 v49, v49
    v_exp_f32 v50, v50
    v_exp_f32 v51, v51
    v_exp_f32 v20, v20
    v_exp_f32 v21, v21
    v_smfmac_f32_32x32x32_bf16 v[92:107], v[160:163], v[44:51], v19
    v_exp_f32 v22, v22
    v_exp_f32 v23, v23
    v_exp_f32 v24, v24
    v_mfma_f32_32x32x16_bf16 v[36:51], v[128:131], v[228:231], 0
    v_exp_f32 v25, v25
    v_exp_f32 v26, v26
    v_exp_f32 v27, v27
    v_exp_f32 v28, v28
    v_exp_f32 v29, v29
    v_exp_f32 v30, v30
    v_smfmac_f32_32x32x32_bf16 v[92:107], v[164:167], v[20:27], v19
    ds_write_b128 v5, v[86:89] offset:27648
    v_exp_f32 v31, v31
    v_exp_f32 v32, v32
    v_exp_f32 v33, v33
    v_exp_f32 v34, v34
    v_exp_f32 v35, v35
    v_exp_f32 v36, v36
    v_exp_f32 v37, v37
    v_smfmac_f32_32x32x32_bf16 v[92:107], v[168:171], v[28:35], v19
    v_exp_f32 v38, v38
    v_exp_f32 v39, v39
    v_exp_f32 v40, v40
    v_mfma_f32_32x32x16_bf16 v[20:35], v[132:135], v[228:231], 0
    v_exp_f32 v41, v41
    v_exp_f32 v42, v42
    v_exp_f32 v43, v43
    v_exp_f32 v44, v44
    v_exp_f32 v45, v45
    v_exp_f32 v46, v46
    v_smfmac_f32_32x32x32_bf16 v[92:107], v[172:175], v[36:43], v19
    ds_write_b32 v6, v90 offset:27648
    v_exp_f32 v47, v47
    v_exp_f32 v48, v48
    v_exp_f32 v49, v49
    v_exp_f32 v50, v50
    v_exp_f32 v51, v51
    v_exp_f32 v20, v20
    v_exp_f32 v21, v21
    v_smfmac_f32_32x32x32_bf16 v[92:107], v[176:179], v[44:51], v19
    v_exp_f32 v22, v22
    v_exp_f32 v23, v23
    v_exp_f32 v24, v24
    v_mfma_f32_32x32x16_bf16 v[36:51], v[136:139], v[228:231], 0
    v_exp_f32 v25, v25
    v_exp_f32 v26, v26
    v_exp_f32 v27, v27
    v_exp_f32 v28, v28
    v_exp_f32 v29, v29
    v_exp_f32 v30, v30
    v_smfmac_f32_32x32x32_bf16 v[92:107], v[180:183], v[20:27], v19
    v_exp_f32 v31, v31
    v_exp_f32 v32, v32
    v_exp_f32 v33, v33
    v_mfma_f32_32x32x16_bf16 v[52:67], v[108:111], v[108:111], 0
    v_exp_f32 v34, v34
    v_exp_f32 v35, v35
    v_exp_f32 v36, v36
    v_exp_f32 v37, v37
    v_smfmac_f32_32x32x32_bf16 v[92:107], v[184:187], v[28:35], v19
    v_exp_f32 v38, v38
    v_exp_f32 v39, v39
    v_exp_f32 v40, v40
    v_mfma_f32_32x32x16_bf16 v[20:35], v[140:143], v[228:231], 0
    v_exp_f32 v41, v41
    v_exp_f32 v42, v42
    v_exp_f32 v43, v43
    v_exp_f32 v44, v44
    v_exp_f32 v45, v45
    v_exp_f32 v46, v46
    v_smfmac_f32_32x32x32_bf16 v[92:107], v[188:191], v[36:43], v19
    v_exp_f32 v47, v47
    v_exp_f32 v48, v48
    v_exp_f32 v49, v49
    v_exp_f32 v50, v50
    v_exp_f32 v51, v51
    v_exp_f32 v20, v20
    v_exp_f32 v21, v21
    v_smfmac_f32_32x32x32_bf16 v[92:107], v[192:195], v[44:51], v19
    v_exp_f32 v22, v22
    v_exp_f32 v23, v23
    v_exp_f32 v24, v24
    v_mfma_f32_32x32x16_bf16 v[36:51], v[144:147], v[228:231], 0
    v_exp_f32 v25, v25
    v_exp_f32 v26, v26
    v_exp_f32 v27, v27
    v_exp_f32 v28, v28
    v_exp_f32 v29, v29
    v_exp_f32 v30, v30
    v_smfmac_f32_32x32x32_bf16 v[92:107], v[196:199], v[20:27], v19
    v_exp_f32 v31, v31
    v_exp_f32 v32, v32
    v_exp_f32 v33, v33
    v_mfma_f32_32x32x16_bf16 v[68:83], v[108:111], v[108:111], 0
    v_exp_f32 v34, v34
    v_exp_f32 v35, v35
    v_exp_f32 v36, v36
    v_exp_f32 v37, v37
    v_smfmac_f32_32x32x32_bf16 v[92:107], v[200:203], v[28:35], v19
    v_exp_f32 v38, v38
    v_exp_f32 v39, v39
    v_exp_f32 v40, v40
    v_mfma_f32_32x32x16_bf16 v[20:35], v[116:119], v[232:235], 0
    v_exp_f32 v41, v41
    v_exp_f32 v42, v42
    v_exp_f32 v43, v43
    v_exp_f32 v44, v44
    v_exp_f32 v45, v45
    v_exp_f32 v46, v46
    v_smfmac_f32_32x32x32_bf16 v[92:107], v[204:207], v[36:43], v19
    v_exp_f32 v47, v47
    v_exp_f32 v48, v48
    v_exp_f32 v49, v49
    v_exp_f32 v50, v50
    v_exp_f32 v51, v51
    v_exp_f32 v20, v20
    v_exp_f32 v21, v21
    v_smfmac_f32_32x32x32_bf16 v[92:107], v[208:211], v[44:51], v19
    v_exp_f32 v22, v22
    v_exp_f32 v23, v23
    v_exp_f32 v24, v24
    v_mfma_f32_32x32x16_bf16 v[36:51], v[120:123], v[232:235], 0
    v_exp_f32 v25, v25
    v_exp_f32 v26, v26
    v_exp_f32 v27, v27
    v_exp_f32 v28, v28
    v_exp_f32 v29, v29
    v_exp_f32 v30, v30
    v_smfmac_f32_32x32x32_bf16 v[52:67], v[148:151], v[20:27], v19
    v_exp_f32 v31, v31
    v_exp_f32 v32, v32
    v_exp_f32 v33, v33
    v_exp_f32 v34, v34
    v_exp_f32 v35, v35
    v_exp_f32 v36, v36
    v_exp_f32 v37, v37
    v_smfmac_f32_32x32x32_bf16 v[52:67], v[152:155], v[28:35], v19
    v_exp_f32 v38, v38
    v_exp_f32 v39, v39
    v_exp_f32 v40, v40
    v_mfma_f32_32x32x16_bf16 v[20:35], v[124:127], v[232:235], 0
    v_exp_f32 v41, v41
    v_exp_f32 v42, v42
    v_exp_f32 v43, v43
    v_exp_f32 v44, v44
    v_exp_f32 v45, v45
    v_exp_f32 v46, v46
    v_smfmac_f32_32x32x32_bf16 v[52:67], v[156:159], v[36:43], v19
    ds_write_b128 v4, v[92:95] offset:36864
    v_exp_f32 v47, v47
    v_exp_f32 v48, v48
    v_exp_f32 v49, v49
    v_exp_f32 v50, v50
    v_exp_f32 v51, v51
    v_exp_f32 v20, v20
    v_exp_f32 v21, v21
    v_smfmac_f32_32x32x32_bf16 v[52:67], v[160:163], v[44:51], v19
    v_exp_f32 v22, v22
    v_exp_f32 v23, v23
    v_exp_f32 v24, v24
    v_mfma_f32_32x32x16_bf16 v[36:51], v[128:131], v[232:235], 0
    v_exp_f32 v25, v25
    v_exp_f32 v26, v26
    v_exp_f32 v27, v27
    v_exp_f32 v28, v28
    v_exp_f32 v29, v29
    v_exp_f32 v30, v30
    v_smfmac_f32_32x32x32_bf16 v[52:67], v[164:167], v[20:27], v19
    ds_write_b128 v5, v[96:99] offset:36864
    v_exp_f32 v31, v31
    v_exp_f32 v32, v32
    v_exp_f32 v33, v33
    v_exp_f32 v34, v34
    v_exp_f32 v35, v35
    v_exp_f32 v36, v36
    v_exp_f32 v37, v37
    v_smfmac_f32_32x32x32_bf16 v[52:67], v[168:171], v[28:35], v19
    v_exp_f32 v38, v38
    v_exp_f32 v39, v39
    v_exp_f32 v40, v40
    v_mfma_f32_32x32x16_bf16 v[20:35], v[132:135], v[232:235], 0
    v_exp_f32 v41, v41
    v_exp_f32 v42, v42
    v_exp_f32 v43, v43
    v_exp_f32 v44, v44
    v_exp_f32 v45, v45
    v_exp_f32 v46, v46
    v_smfmac_f32_32x32x32_bf16 v[52:67], v[172:175], v[36:43], v19
    ds_write_b32 v6, v100 offset:36864
    v_exp_f32 v47, v47
    v_exp_f32 v48, v48
    v_exp_f32 v49, v49
    v_exp_f32 v50, v50
    v_exp_f32 v51, v51
    v_exp_f32 v20, v20
    v_exp_f32 v21, v21
    v_smfmac_f32_32x32x32_bf16 v[52:67], v[176:179], v[44:51], v19
    v_exp_f32 v22, v22
    v_exp_f32 v23, v23
    v_exp_f32 v24, v24
    v_mfma_f32_32x32x16_bf16 v[36:51], v[136:139], v[232:235], 0
    v_exp_f32 v25, v25
    v_exp_f32 v26, v26
    v_exp_f32 v27, v27
    v_exp_f32 v28, v28
    v_exp_f32 v29, v29
    v_exp_f32 v30, v30
    v_smfmac_f32_32x32x32_bf16 v[52:67], v[180:183], v[20:27], v19
    v_exp_f32 v31, v31
    v_exp_f32 v32, v32
    v_exp_f32 v33, v33
    v_exp_f32 v34, v34
    v_exp_f32 v35, v35
    v_exp_f32 v36, v36
    v_exp_f32 v37, v37
    v_smfmac_f32_32x32x32_bf16 v[52:67], v[184:187], v[28:35], v19
    v_exp_f32 v38, v38
    v_exp_f32 v39, v39
    v_exp_f32 v40, v40
    v_mfma_f32_32x32x16_bf16 v[20:35], v[140:143], v[232:235], 0
    v_exp_f32 v41, v41
    v_exp_f32 v42, v42
    v_exp_f32 v43, v43
    v_exp_f32 v44, v44
    v_exp_f32 v45, v45
    v_exp_f32 v46, v46
    v_smfmac_f32_32x32x32_bf16 v[52:67], v[188:191], v[36:43], v19
    v_exp_f32 v47, v47
    v_exp_f32 v48, v48
    v_exp_f32 v49, v49
    v_exp_f32 v50, v50
    v_exp_f32 v51, v51
    v_exp_f32 v20, v20
    v_exp_f32 v21, v21
    v_smfmac_f32_32x32x32_bf16 v[52:67], v[192:195], v[44:51], v19
    v_exp_f32 v22, v22
    v_exp_f32 v23, v23
    v_exp_f32 v24, v24
    v_mfma_f32_32x32x16_bf16 v[36:51], v[144:147], v[232:235], 0
    v_exp_f32 v25, v25
    v_exp_f32 v26, v26
    v_exp_f32 v27, v27
    v_exp_f32 v28, v28
    v_exp_f32 v29, v29
    v_exp_f32 v30, v30
    v_smfmac_f32_32x32x32_bf16 v[52:67], v[196:199], v[20:27], v19
    v_exp_f32 v31, v31
    v_exp_f32 v32, v32
    v_exp_f32 v33, v33
    v_exp_f32 v34, v34
    v_exp_f32 v35, v35
    v_exp_f32 v36, v36
    v_exp_f32 v37, v37
    v_smfmac_f32_32x32x32_bf16 v[52:67], v[200:203], v[28:35], v19
    v_exp_f32 v38, v38
    v_exp_f32 v39, v39
    v_exp_f32 v40, v40
    v_mfma_f32_32x32x16_bf16 v[20:35], v[116:119], v[236:239], 0
    v_exp_f32 v41, v41
    v_exp_f32 v42, v42
    v_exp_f32 v43, v43
    v_exp_f32 v44, v44
    v_exp_f32 v45, v45
    v_exp_f32 v46, v46
    v_smfmac_f32_32x32x32_bf16 v[52:67], v[204:207], v[36:43], v19
    v_exp_f32 v47, v47
    v_exp_f32 v48, v48
    v_exp_f32 v49, v49
    v_exp_f32 v50, v50
    v_exp_f32 v51, v51
    v_exp_f32 v20, v20
    v_exp_f32 v21, v21
    v_smfmac_f32_32x32x32_bf16 v[52:67], v[208:211], v[44:51], v19
    v_exp_f32 v22, v22
    v_exp_f32 v23, v23
    v_exp_f32 v24, v24
    v_mfma_f32_32x32x16_bf16 v[36:51], v[120:123], v[236:239], 0
    v_exp_f32 v25, v25
    v_exp_f32 v26, v26
    v_exp_f32 v27, v27
    v_exp_f32 v28, v28
    v_exp_f32 v29, v29
    v_exp_f32 v30, v30
    v_smfmac_f32_32x32x32_bf16 v[62:77], v[148:151], v[20:27], v19
    v_exp_f32 v31, v31
    v_exp_f32 v32, v32
    v_exp_f32 v33, v33
    v_exp_f32 v34, v34
    v_exp_f32 v35, v35
    v_exp_f32 v36, v36
    v_exp_f32 v37, v37
    v_smfmac_f32_32x32x32_bf16 v[62:77], v[152:155], v[28:35], v19
    v_exp_f32 v38, v38
    v_exp_f32 v39, v39
    v_exp_f32 v40, v40
    v_mfma_f32_32x32x16_bf16 v[20:35], v[124:127], v[236:239], 0
    v_exp_f32 v41, v41
    v_exp_f32 v42, v42
    v_exp_f32 v43, v43
    v_exp_f32 v44, v44
    v_exp_f32 v45, v45
    v_exp_f32 v46, v46
    v_smfmac_f32_32x32x32_bf16 v[62:77], v[156:159], v[36:43], v19
    v_exp_f32 v47, v47
    v_exp_f32 v48, v48
    v_exp_f32 v49, v49
    v_exp_f32 v50, v50
    v_exp_f32 v51, v51
    v_exp_f32 v20, v20
    v_exp_f32 v21, v21
    v_smfmac_f32_32x32x32_bf16 v[62:77], v[160:163], v[44:51], v19
    v_exp_f32 v22, v22
    v_exp_f32 v23, v23
    v_exp_f32 v24, v24
    v_mfma_f32_32x32x16_bf16 v[36:51], v[128:131], v[236:239], 0
    v_exp_f32 v25, v25
    v_exp_f32 v26, v26
    v_exp_f32 v27, v27
    v_exp_f32 v28, v28
    v_exp_f32 v29, v29
    v_exp_f32 v30, v30
    v_smfmac_f32_32x32x32_bf16 v[62:77], v[164:167], v[20:27], v19
    v_exp_f32 v31, v31
    v_exp_f32 v32, v32
    v_exp_f32 v33, v33
    v_exp_f32 v34, v34
    v_exp_f32 v35, v35
    v_exp_f32 v36, v36
    v_exp_f32 v37, v37
    v_smfmac_f32_32x32x32_bf16 v[62:77], v[168:171], v[28:35], v19
    v_exp_f32 v38, v38
    v_exp_f32 v39, v39
    v_exp_f32 v40, v40
    v_mfma_f32_32x32x16_bf16 v[20:35], v[132:135], v[236:239], 0
    v_exp_f32 v41, v41
    v_exp_f32 v42, v42
    v_exp_f32 v43, v43
    v_exp_f32 v44, v44
    v_exp_f32 v45, v45
    v_exp_f32 v46, v46
    v_smfmac_f32_32x32x32_bf16 v[62:77], v[172:175], v[36:43], v19
    v_exp_f32 v47, v47
    v_exp_f32 v48, v48
    v_exp_f32 v49, v49
    v_exp_f32 v50, v50
    v_exp_f32 v51, v51
    v_exp_f32 v20, v20
    v_exp_f32 v21, v21
    v_smfmac_f32_32x32x32_bf16 v[62:77], v[176:179], v[44:51], v19
    v_exp_f32 v22, v22
    v_exp_f32 v23, v23
    v_exp_f32 v24, v24
    v_mfma_f32_32x32x16_bf16 v[36:51], v[136:139], v[236:239], 0
    v_exp_f32 v25, v25
    v_exp_f32 v26, v26
    v_exp_f32 v27, v27
    v_exp_f32 v28, v28
    v_exp_f32 v29, v29
    v_exp_f32 v30, v30
    v_smfmac_f32_32x32x32_bf16 v[62:77], v[180:183], v[20:27], v19
    v_exp_f32 v31, v31
    v_exp_f32 v32, v32
    v_exp_f32 v33, v33
    v_exp_f32 v34, v34
    v_exp_f32 v35, v35
    v_exp_f32 v36, v36
    v_exp_f32 v37, v37
    v_smfmac_f32_32x32x32_bf16 v[62:77], v[184:187], v[28:35], v19
    v_exp_f32 v38, v38
    v_exp_f32 v39, v39
    v_exp_f32 v40, v40
    v_mfma_f32_32x32x16_bf16 v[20:35], v[140:143], v[236:239], 0
    v_exp_f32 v41, v41
    v_exp_f32 v42, v42
    v_exp_f32 v43, v43
    v_exp_f32 v44, v44
    v_exp_f32 v45, v45
    v_exp_f32 v46, v46
    v_smfmac_f32_32x32x32_bf16 v[62:77], v[188:191], v[36:43], v19
    v_exp_f32 v47, v47
    v_exp_f32 v48, v48
    v_exp_f32 v49, v49
    v_exp_f32 v50, v50
    v_exp_f32 v51, v51
    v_exp_f32 v20, v20
    v_exp_f32 v21, v21
    v_smfmac_f32_32x32x32_bf16 v[62:77], v[192:195], v[44:51], v19
    v_exp_f32 v22, v22
    v_exp_f32 v23, v23
    v_exp_f32 v24, v24
    v_mfma_f32_32x32x16_bf16 v[36:51], v[144:147], v[236:239], 0
    v_exp_f32 v25, v25
    v_exp_f32 v26, v26
    v_exp_f32 v27, v27
    v_exp_f32 v28, v28
    v_exp_f32 v29, v29
    v_exp_f32 v30, v30
    v_smfmac_f32_32x32x32_bf16 v[62:77], v[196:199], v[20:27], v19
    v_exp_f32 v31, v31
    v_exp_f32 v32, v32
    v_exp_f32 v33, v33
    v_exp_f32 v34, v34
    v_exp_f32 v35, v35
    v_exp_f32 v36, v36
    v_exp_f32 v37, v37
    v_smfmac_f32_32x32x32_bf16 v[62:77], v[200:203], v[28:35], v19
    v_exp_f32 v38, v38
    v_exp_f32 v39, v39
    v_exp_f32 v40, v40
    v_mfma_f32_32x32x16_bf16 v[20:35], v[116:119], v[240:243], 0
    v_exp_f32 v41, v41
    v_exp_f32 v42, v42
    v_exp_f32 v43, v43
    v_exp_f32 v44, v44
    v_exp_f32 v45, v45
    v_exp_f32 v46, v46
    v_smfmac_f32_32x32x32_bf16 v[62:77], v[204:207], v[36:43], v19
    v_exp_f32 v47, v47
    v_exp_f32 v48, v48
    v_exp_f32 v49, v49
    v_exp_f32 v50, v50
    v_exp_f32 v51, v51
    v_exp_f32 v20, v20
    v_exp_f32 v21, v21
    v_smfmac_f32_32x32x32_bf16 v[62:77], v[208:211], v[44:51], v19
    v_exp_f32 v22, v22
    v_exp_f32 v23, v23
    v_exp_f32 v24, v24
    v_mfma_f32_32x32x16_bf16 v[36:51], v[120:123], v[240:243], 0
    v_exp_f32 v25, v25
    v_exp_f32 v26, v26
    v_exp_f32 v27, v27
    v_exp_f32 v28, v28
    v_exp_f32 v29, v29
    v_exp_f32 v30, v30
    v_smfmac_f32_32x32x32_bf16 v[72:87], v[148:151], v[20:27], v19
    v_exp_f32 v31, v31
    v_exp_f32 v32, v32
    v_exp_f32 v33, v33
    v_exp_f32 v34, v34
    v_exp_f32 v35, v35
    v_exp_f32 v36, v36
    v_exp_f32 v37, v37
    v_smfmac_f32_32x32x32_bf16 v[72:87], v[152:155], v[28:35], v19
    v_exp_f32 v38, v38
    v_exp_f32 v39, v39
    v_exp_f32 v40, v40
    v_mfma_f32_32x32x16_bf16 v[20:35], v[124:127], v[240:243], 0
    v_exp_f32 v41, v41
    v_exp_f32 v42, v42
    v_exp_f32 v43, v43
    v_exp_f32 v44, v44
    v_exp_f32 v45, v45
    v_exp_f32 v46, v46
    v_smfmac_f32_32x32x32_bf16 v[72:87], v[156:159], v[36:43], v19
    v_exp_f32 v47, v47
    v_exp_f32 v48, v48
    v_exp_f32 v49, v49
    v_exp_f32 v50, v50
    v_exp_f32 v51, v51
    v_exp_f32 v20, v20
    v_exp_f32 v21, v21
    v_smfmac_f32_32x32x32_bf16 v[72:87], v[160:163], v[44:51], v19
    v_exp_f32 v22, v22
    v_exp_f32 v23, v23
    v_exp_f32 v24, v24
    v_mfma_f32_32x32x16_bf16 v[36:51], v[128:131], v[240:243], 0
    v_exp_f32 v25, v25
    v_exp_f32 v26, v26
    v_exp_f32 v27, v27
    v_exp_f32 v28, v28
    v_exp_f32 v29, v29
    v_exp_f32 v30, v30
    v_smfmac_f32_32x32x32_bf16 v[72:87], v[164:167], v[20:27], v19
    v_exp_f32 v31, v31
    v_exp_f32 v32, v32
    v_exp_f32 v33, v33
    v_exp_f32 v34, v34
    v_exp_f32 v35, v35
    v_exp_f32 v36, v36
    v_exp_f32 v37, v37
    v_smfmac_f32_32x32x32_bf16 v[72:87], v[168:171], v[28:35], v19
    v_exp_f32 v38, v38
    v_exp_f32 v39, v39
    v_exp_f32 v40, v40
    v_mfma_f32_32x32x16_bf16 v[20:35], v[132:135], v[240:243], 0
    v_exp_f32 v41, v41
    v_exp_f32 v42, v42
    v_exp_f32 v43, v43
    v_exp_f32 v44, v44
    v_exp_f32 v45, v45
    v_exp_f32 v46, v46
    v_smfmac_f32_32x32x32_bf16 v[72:87], v[172:175], v[36:43], v19
    v_exp_f32 v47, v47
    v_exp_f32 v48, v48
    v_exp_f32 v49, v49
    v_exp_f32 v50, v50
    v_exp_f32 v51, v51
    v_exp_f32 v20, v20
    v_exp_f32 v21, v21
    v_smfmac_f32_32x32x32_bf16 v[72:87], v[176:179], v[44:51], v19
    s_waitcnt lgkmcnt(0)
    s_barrier
    v_exp_f32 v22, v22
    v_exp_f32 v23, v23
    v_exp_f32 v24, v24
    v_mfma_f32_32x32x16_bf16 v[36:51], v[136:139], v[240:243], 0
    v_exp_f32 v25, v25
    v_exp_f32 v26, v26
    v_exp_f32 v27, v27
    v_exp_f32 v28, v28
    v_exp_f32 v29, v29
    v_exp_f32 v30, v30
    v_smfmac_f32_32x32x32_bf16 v[72:87], v[180:183], v[20:27], v19
    v_exp_f32 v31, v31
    v_exp_f32 v32, v32
    v_exp_f32 v33, v33
    v_exp_f32 v34, v34
    v_exp_f32 v35, v35
    v_exp_f32 v36, v36
    v_exp_f32 v37, v37
    v_smfmac_f32_32x32x32_bf16 v[72:87], v[184:187], v[28:35], v19
    v_exp_f32 v38, v38
    v_exp_f32 v39, v39
    v_exp_f32 v40, v40
    v_mfma_f32_32x32x16_bf16 v[20:35], v[140:143], v[240:243], 0
    v_exp_f32 v41, v41
    v_exp_f32 v42, v42
    v_exp_f32 v43, v43
    v_exp_f32 v44, v44
    v_exp_f32 v45, v45
    v_exp_f32 v46, v46
    v_smfmac_f32_32x32x32_bf16 v[72:87], v[188:191], v[36:43], v19
    v_exp_f32 v47, v47
    v_exp_f32 v48, v48
    v_exp_f32 v49, v49
    v_exp_f32 v50, v50
    v_exp_f32 v51, v51
    v_exp_f32 v20, v20
    v_exp_f32 v21, v21
    v_smfmac_f32_32x32x32_bf16 v[72:87], v[192:195], v[44:51], v19
    v_exp_f32 v22, v22
    v_exp_f32 v23, v23
    v_exp_f32 v24, v24
    v_mfma_f32_32x32x16_bf16 v[36:51], v[144:147], v[240:243], 0
    v_exp_f32 v25, v25
    v_exp_f32 v26, v26
    v_exp_f32 v27, v27
    v_exp_f32 v28, v28
    v_exp_f32 v29, v29
    v_exp_f32 v30, v30
    v_smfmac_f32_32x32x32_bf16 v[72:87], v[196:199], v[20:27], v19
    v_exp_f32 v31, v31
    v_exp_f32 v32, v32
    v_exp_f32 v33, v33
    v_exp_f32 v34, v34
    v_exp_f32 v35, v35
    v_exp_f32 v36, v36
    v_exp_f32 v37, v37
    v_smfmac_f32_32x32x32_bf16 v[72:87], v[200:203], v[28:35], v19
    v_exp_f32 v38, v38
    v_exp_f32 v39, v39
    v_exp_f32 v40, v40
    v_exp_f32 v41, v41
    v_exp_f32 v42, v42
    v_exp_f32 v43, v43
    v_exp_f32 v44, v44
    v_exp_f32 v45, v45
    v_exp_f32 v46, v46
    v_smfmac_f32_32x32x32_bf16 v[72:87], v[204:207], v[36:43], v19
    v_exp_f32 v47, v47
    v_exp_f32 v48, v48
    v_exp_f32 v49, v49
    v_exp_f32 v50, v50
    v_exp_f32 v51, v51
    s_nop 3
    v_smfmac_f32_32x32x32_bf16 v[72:87], v[208:211], v[44:51], v19
    ds_write_b128 v4, v[52:55] offset:46080
    ds_write_b128 v5, v[56:59] offset:46080
    ds_write_b32 v6, v60 offset:46080
    ds_write_b128 v4, v[62:65] offset:55296
    ds_write_b128 v5, v[66:69] offset:55296
    ds_write_b32 v6, v70 offset:55296
    s_nop 5
    ds_write_b128 v4, v[72:75] offset:64512
    ds_write_b128 v5, v[76:79] offset:64512
    ds_write_b32 v6, v80 offset:64512
    s_waitcnt lgkmcnt(0)
    s_setprio 1
    s_lshl_b32 s76, s75, 3
    s_lshl_b32 s78, s16, 1
    s_add_u32 s76, s76, s78
    s_lshl_b32 s78, s74, 17
    s_lshl_b32 s79, s76, 11
    s_add_u32 s78, s78, s79
    s_add_u32 s78, s78, 7340032
    buffer_load_dwordx4 v[84:87], v17, s[44:47], s78 offen offset:0 sc1
    buffer_load_dwordx4 v[88:91], v17, s[44:47], s78 offen offset:1024 sc1
    buffer_load_dwordx4 v[92:95], v17, s[44:47], s78 offen offset:2048 sc1
    buffer_load_dwordx4 v[96:99], v17, s[44:47], s78 offen offset:3072 sc1
    ds_read_b128 v[20:23], v17 offset:8192
    ds_read_b128 v[24:27], v17 offset:9216
    s_lshl_b32 s78, s76, 5
    s_add_u32 s78, s78, s74
    s_lshl_b32 s81, s78, 10
    s_add_u32 s81, s81, 15728640
    s_add_u32 s82, s81, 32768
    s_lshl_b32 s83, s78, 3
    s_add_u32 s83, s83, 53248
    s_waitcnt vmcnt(0) lgkmcnt(0)
    v_mfma_f32_32x32x16_bf16 v[28:43], v[20:23], v[84:87], 0
    v_mfma_f32_32x32x16_bf16 v[28:43], v[24:27], v[88:91], v[28:43]
    v_mfma_f32_32x32x16_bf16 v[44:59], v[20:23], v[92:95], 0
    v_mfma_f32_32x32x16_bf16 v[44:59], v[24:27], v[96:99], v[44:59]
    s_nop 9
    v_add_f32 v36, 0x358637bd, v36
    v_rcp_f32 v36, v36
    s_nop 0
    v_mul_f32 v28, v28, v36
    v_mul_f32 v29, v29, v36
    v_mul_f32 v30, v30, v36
    v_mul_f32 v31, v31, v36
    v_mul_f32 v32, v32, v36
    v_mul_f32 v33, v33, v36
    v_mul_f32 v34, v34, v36
    v_mul_f32 v35, v35, v36
    v_cvt_pk_bf16_f32 v100, v28, v29
    v_cvt_pk_bf16_f32 v101, v30, v31
    v_cvt_pk_bf16_f32 v102, v32, v33
    v_cvt_pk_bf16_f32 v103, v34, v35
    buffer_store_dwordx4 v[100:103], v17, s[44:47], s81 offen sc1
    v_add_f32 v52, 0x358637bd, v52
    v_rcp_f32 v52, v52
    s_nop 0
    v_mul_f32 v44, v44, v52
    v_mul_f32 v45, v45, v52
    v_mul_f32 v46, v46, v52
    v_mul_f32 v47, v47, v52
    v_mul_f32 v48, v48, v52
    v_mul_f32 v49, v49, v52
    v_mul_f32 v50, v50, v52
    v_mul_f32 v51, v51, v52
    v_cvt_pk_bf16_f32 v104, v44, v45
    v_cvt_pk_bf16_f32 v105, v46, v47
    v_cvt_pk_bf16_f32 v106, v48, v49
    v_cvt_pk_bf16_f32 v107, v50, v51
    buffer_store_dwordx4 v[104:107], v17, s[44:47], s82 offen sc1
    s_lshl_b32 s3, s83, 3
    s_add_u32 s3, s3, 19922944
    s_waitcnt vmcnt(0)
    s_mov_b64 exec, 1
    buffer_store_dwordx2 v[250:251], v252, s[44:47], s3 offen sc1
    s_add_u32 s3, s3, 2048
    buffer_store_dwordx2 v[250:251], v252, s[44:47], s3 offen sc1
    s_mov_b64 exec, -1
    s_lshl_b32 s76, s73, 2
    s_add_u32 s76, s76, s14
    s_lshl_b32 s78, s76, 8
    s_add_u32 s78, s78, 53248
    v_lshl_add_u32 v253, v14, 1, s78
    v_lshrrev_b32 v2, 2, v1
    v_and_b32 v3, 3, v1
    v_lshlrev_b32 v3, 4, v3
    v_lshl_add_u32 v3, v2, 10, v3
    s_and_b32 s78, s16, 1
    s_lshl_b32 s78, s78, 18
    s_add_u32 s78, s78, s15
    s_lshl_b32 s79, s16, 14
    s_add_u32 s79, s79, 106496
    s_add_u32 s78, s78, 131072
    s_mov_b32 s80, 8
L_wo8:
    s_mov_b32 m0, s79
    s_add_u32 s79, s79, 1024
    buffer_load_dwordx4 v3, s[40:43], s78 offen lds
    s_add_u32 s78, s78, 16384
    s_sub_u32 s80, s80, 1
    s_cmp_lg_u32 s80, 0
    s_cbranch_scc1 L_wo8
    s_mov_b32 s3, 19922944
    s_mov_b32 s88, 0x100000
    v_lshlrev_b32 v253, 3, v253
L_poll7:
    buffer_load_dwordx2 v[248:249], v253, s[44:47], s3 offen sc1
    s_waitcnt vmcnt(0)
    v_cmp_ne_u64 vcc, s[26:27], v[248:249]
    s_cmp_eq_u64 vcc, 0
    s_cbranch_scc1 L_polld7
    s_sub_u32 s88, s88, 1
    s_cmp_eq_u32 s88, 0
    s_cbranch_scc1 L_polld7
    s_sleep 1
    s_branch L_poll7
L_polld7:
    s_lshl_b32 s84, s76, 15
    s_add_u32 s84, s84, 15728640
    s_lshl_b32 s79, s14, 7
    s_add_u32 s79, s79, 131072
    buffer_load_dword v244, v16, s[44:47], s79 offen sc1
    s_lshl_b32 s79, s76, 7
    s_add_u32 s79, s79, 131072
    buffer_load_dword v245, v14, s[44:47], s79 offen sc1
    buffer_load_dwordx4 v[20:23], v17, s[44:47], s84 offen offset:0 sc1
    buffer_load_dwordx4 v[24:27], v17, s[44:47], s84 offen offset:1024 sc1
    buffer_load_dwordx4 v[28:31], v17, s[44:47], s84 offen offset:2048 sc1
    buffer_load_dwordx4 v[32:35], v17, s[44:47], s84 offen offset:3072 sc1
    s_add_u32 s84, s84, 4096
    buffer_load_dwordx4 v[36:39], v17, s[44:47], s84 offen offset:0 sc1
    buffer_load_dwordx4 v[40:43], v17, s[44:47], s84 offen offset:1024 sc1
    buffer_load_dwordx4 v[44:47], v17, s[44:47], s84 offen offset:2048 sc1
    buffer_load_dwordx4 v[48:51], v17, s[44:47], s84 offen offset:3072 sc1
    s_add_u32 s84, s84, 4096
    buffer_load_dwordx4 v[52:55], v17, s[44:47], s84 offen offset:0 sc1
    buffer_load_dwordx4 v[56:59], v17, s[44:47], s84 offen offset:1024 sc1
    buffer_load_dwordx4 v[60:63], v17, s[44:47], s84 offen offset:2048 sc1
    buffer_load_dwordx4 v[64:67], v17, s[44:47], s84 offen offset:3072 sc1
    s_add_u32 s84, s84, 4096
    s_barrier
    ds_read_b32 v156, v12 offset:2048
    ds_read_b32 v168, v12 offset:4352
    ds_read_b32 v180, v12 offset:6656
    ds_read_b32 v192, v12 offset:8960
    ds_read_b128 v[148:151], v11 offset:0
    ds_read_b128 v[152:155], v11 offset:1024
    ds_read_b128 v[160:163], v11 offset:2304
    ds_read_b128 v[164:167], v11 offset:3328
    ds_read_b128 v[172:175], v11 offset:4608
    ds_read_b128 v[176:179], v11 offset:5632
    ds_read_b128 v[184:187], v11 offset:6912
    ds_read_b128 v[188:191], v11 offset:7936
    s_waitcnt lgkmcnt(8)
    v_add_f32 v156, v156, v168
    v_add_f32 v180, v180, v192
    v_add_f32 v156, v156, v180
    v_rcp_f32 v158, v156
    s_waitcnt lgkmcnt(4)
    v_add_f32 v148, v148, v160
    v_add_f32 v149, v149, v161
    v_add_f32 v150, v150, v162
    v_add_f32 v151, v151, v163
    v_add_f32 v152, v152, v164
    v_add_f32 v153, v153, v165
    v_add_f32 v154, v154, v166
    v_add_f32 v155, v155, v167
    s_waitcnt lgkmcnt(2)
    v_add_f32 v148, v148, v172
    v_add_f32 v149, v149, v173
    v_add_f32 v150, v150, v174
    v_add_f32 v151, v151, v175
    v_add_f32 v152, v152, v176
    v_add_f32 v153, v153, v177
    v_add_f32 v154, v154, v178
    v_add_f32 v155, v155, v179
    s_waitcnt lgkmcnt(0)
    v_add_f32 v148, v148, v184
    v_add_f32 v149, v149, v185
    v_add_f32 v150, v150, v186
    v_add_f32 v151, v151, v187
    v_add_f32 v152, v152, v188
    v_add_f32 v153, v153, v189
    v_add_f32 v154, v154, v190
    v_add_f32 v155, v155, v191
    v_mul_f32 v2, 0, v148
    v_mul_f32 v3, 0, v149
    v_fma_f32 v2, v150, 0, v2
    v_fma_f32 v3, v151, 0, v3
    v_fma_f32 v2, v152, 0, v2
    v_fma_f32 v3, v153, 0, v3
    v_fma_f32 v2, v154, 0, v2
    v_fma_f32 v3, v155, 0, v3
    v_add_f32 v2, v2, v3
    v_add_f32 v2, v2, v156
    v_cmp_le_f32 vcc, 1.0, v2
    v_cmp_ge_f32 s[78:79], s21, v2
    v_mul_f32 v148, v148, v158
    v_mul_f32 v149, v149, v158
    v_mul_f32 v150, v150, v158
    v_mul_f32 v151, v151, v158
    v_mul_f32 v152, v152, v158
    v_mul_f32 v153, v153, v158
    v_mul_f32 v154, v154, v158
    v_mul_f32 v155, v155, v158
    s_and_b64 vcc, vcc, s[78:79]
    s_cmp_eq_u64 vcc, -1
    s_cbranch_scc1 L_ok8
    s_swappc_b64 s[6:7], s[8:9]
L_ok8:
    v_cvt_pk_bf16_f32 v160, v148, v149
    v_cvt_pk_bf16_f32 v161, v150, v151
    v_cvt_pk_bf16_f32 v162, v152, v153
    v_cvt_pk_bf16_f32 v163, v154, v155
    v_min_u32 v160, -2, v160
    v_min_u32 v161, -2, v161
    v_min_u32 v162, -2, v162
    v_min_u32 v163, -2, v163
    buffer_store_dwordx4 v[160:163], v17, s[44:47], s23 offen sc1
    s_lshl_b32 s3, s22, 3
    s_add_u32 s3, s3, 19922944
    s_waitcnt vmcnt(0)
    s_mov_b64 exec, 1
    buffer_store_dwordx2 v[250:251], v252, s[44:47], s3 offen sc1
    s_mov_b64 exec, -1
    buffer_load_dwordx4 v[68:71], v17, s[44:47], s84 offen offset:0 sc1
    buffer_load_dwordx4 v[72:75], v17, s[44:47], s84 offen offset:1024 sc1
    buffer_load_dwordx4 v[76:79], v17, s[44:47], s84 offen offset:2048 sc1
    buffer_load_dwordx4 v[80:83], v17, s[44:47], s84 offen offset:3072 sc1
    s_add_u32 s84, s84, 4096
    buffer_load_dwordx4 v[84:87], v17, s[44:47], s84 offen offset:0 sc1
    buffer_load_dwordx4 v[88:91], v17, s[44:47], s84 offen offset:1024 sc1
    buffer_load_dwordx4 v[92:95], v17, s[44:47], s84 offen offset:2048 sc1
    buffer_load_dwordx4 v[96:99], v17, s[44:47], s84 offen offset:3072 sc1
    s_add_u32 s84, s84, 4096
    buffer_load_dwordx4 v[100:103], v17, s[44:47], s84 offen offset:0 sc1
    buffer_load_dwordx4 v[104:107], v17, s[44:47], s84 offen offset:1024 sc1
    buffer_load_dwordx4 v[108:111], v17, s[44:47], s84 offen offset:2048 sc1
    buffer_load_dwordx4 v[112:115], v17, s[44:47], s84 offen offset:3072 sc1
    s_add_u32 s84, s84, 4096
    buffer_load_dwordx4 v[116:119], v17, s[44:47], s84 offen offset:0 sc1
    buffer_load_dwordx4 v[120:123], v17, s[44:47], s84 offen offset:1024 sc1
    buffer_load_dwordx4 v[124:127], v17, s[44:47], s84 offen offset:2048 sc1
    buffer_load_dwordx4 v[128:131], v17, s[44:47], s84 offen offset:3072 sc1
    s_add_u32 s84, s84, 4096
    buffer_load_dwordx4 v[132:135], v17, s[44:47], s84 offen offset:0 sc1
    buffer_load_dwordx4 v[136:139], v17, s[44:47], s84 offen offset:1024 sc1
    buffer_load_dwordx4 v[140:143], v17, s[44:47], s84 offen offset:2048 sc1
    buffer_load_dwordx4 v[144:147], v17, s[44:47], s84 offen offset:3072 sc1
    s_mov_b32 s3, 19922944
    s_mov_b32 s88, 0x100000
    v_lshlrev_b32 v15, 3, v15
L_poll9:
    buffer_load_dwordx2 v[248:249], v15, s[44:47], s3 offen sc1
    s_waitcnt vmcnt(0)
    v_cmp_ne_u64 vcc, s[26:27], v[248:249]
    s_cmp_eq_u64 vcc, 0
    s_cbranch_scc1 L_polld9
    s_sub_u32 s88, s88, 1
    s_cmp_eq_u32 s88, 0
    s_cbranch_scc1 L_polld9
    s_sleep 1
    s_branch L_poll9
L_polld9:
    buffer_load_dwordx4 v[148:151], v17, s[44:47], s72 offen offset:0 sc1
    buffer_load_dwordx4 v[152:155], v17, s[44:47], s72 offen offset:1024 sc1
    buffer_load_dwordx4 v[156:159], v17, s[44:47], s72 offen offset:2048 sc1
    buffer_load_dwordx4 v[160:163], v17, s[44:47], s72 offen offset:3072 sc1
    s_add_u32 s72, s72, 4096
    buffer_load_dwordx4 v[164:167], v17, s[44:47], s72 offen offset:0 sc1
    buffer_load_dwordx4 v[168:171], v17, s[44:47], s72 offen offset:1024 sc1
    buffer_load_dwordx4 v[172:175], v17, s[44:47], s72 offen offset:2048 sc1
    buffer_load_dwordx4 v[176:179], v17, s[44:47], s72 offen offset:3072 sc1
    s_add_u32 s72, s72, 4096
    buffer_load_dwordx4 v[180:183], v17, s[44:47], s72 offen offset:0 sc1
    buffer_load_dwordx4 v[184:187], v17, s[44:47], s72 offen offset:1024 sc1
    buffer_load_dwordx4 v[188:191], v17, s[44:47], s72 offen offset:2048 sc1
    buffer_load_dwordx4 v[192:195], v17, s[44:47], s72 offen offset:3072 sc1
    s_add_u32 s72, s72, 4096
    buffer_load_dwordx4 v[196:199], v17, s[44:47], s72 offen offset:0 sc1
    buffer_load_dwordx4 v[200:203], v17, s[44:47], s72 offen offset:1024 sc1
    buffer_load_dwordx4 v[204:207], v17, s[44:47], s72 offen offset:2048 sc1
    buffer_load_dwordx4 v[208:211], v17, s[44:47], s72 offen offset:3072 sc1
    v_sub_f32 v245, 1.0, v245
    ds_read_b64_tr_b16 v[228:229], v13 offset:0
    ds_read_b64_tr_b16 v[230:231], v13 offset:512
    ds_read_b64_tr_b16 v[232:233], v13 offset:1024
    ds_read_b64_tr_b16 v[234:235], v13 offset:1536
    ds_read_b64_tr_b16 v[236:237], v13 offset:2048
    ds_read_b64_tr_b16 v[238:239], v13 offset:2560
    s_barrier
    s_waitcnt vmcnt(0)
    ds_read_b64_tr_b16 v[240:241], v13 offset:3072
    ds_read_b64_tr_b16 v[242:243], v13 offset:3584
    s_waitcnt lgkmcnt(6)
    v_mfma_f32_32x32x16_bf16 v[212:227], v[228:231], v[148:151], 0
    ds_read_b64_tr_b16 v[228:229], v13 offset:4096
    ds_read_b64_tr_b16 v[230:231], v13 offset:4608
    s_waitcnt lgkmcnt(6)
    v_mfma_f32_32x32x16_bf16 v[212:227], v[232:235], v[152:155], v[212:227]
    ds_read_b64_tr_b16 v[232:233], v13 offset:5120
    ds_read_b64_tr_b16 v[234:235], v13 offset:5632
    s_waitcnt lgkmcnt(6)
    v_mfma_f32_32x32x16_bf16 v[212:227], v[236:239], v[156:159], v[212:227]
    ds_read_b64_tr_b16 v[236:237], v13 offset:6144
    ds_read_b64_tr_b16 v[238:239], v13 offset:6656
    s_waitcnt lgkmcnt(6)
    v_mfma_f32_32x32x16_bf16 v[212:227], v[240:243], v[160:163], v[212:227]
    ds_read_b64_tr_b16 v[240:241], v13 offset:7168
    ds_read_b64_tr_b16 v[242:243], v13 offset:7680
    s_waitcnt lgkmcnt(6)
    v_mfma_f32_32x32x16_bf16 v[212:227], v[228:231], v[164:167], v[212:227]
    ds_read_b64_tr_b16 v[228:229], v13 offset:8192
    ds_read_b64_tr_b16 v[230:231], v13 offset:8704
    s_waitcnt lgkmcnt(6)
    v_mfma_f32_32x32x16_bf16 v[212:227], v[232:235], v[168:171], v[212:227]
    ds_read_b64_tr_b16 v[232:233], v13 offset:9216
    ds_read_b64_tr_b16 v[234:235], v13 offset:9728
    s_waitcnt lgkmcnt(6)
    v_mfma_f32_32x32x16_bf16 v[212:227], v[236:239], v[172:175], v[212:227]
    ds_read_b64_tr_b16 v[236:237], v13 offset:10240
    ds_read_b64_tr_b16 v[238:239], v13 offset:10752
    s_waitcnt lgkmcnt(6)
    v_mfma_f32_32x32x16_bf16 v[212:227], v[240:243], v[176:179], v[212:227]
    ds_read_b64_tr_b16 v[240:241], v13 offset:11264
    ds_read_b64_tr_b16 v[242:243], v13 offset:11776
    s_waitcnt lgkmcnt(6)
    v_mfma_f32_32x32x16_bf16 v[212:227], v[228:231], v[180:183], v[212:227]
    ds_read_b64_tr_b16 v[228:229], v13 offset:12288
    ds_read_b64_tr_b16 v[230:231], v13 offset:12800
    s_waitcnt lgkmcnt(6)
    v_mfma_f32_32x32x16_bf16 v[212:227], v[232:235], v[184:187], v[212:227]
    ds_read_b64_tr_b16 v[232:233], v13 offset:13312
    ds_read_b64_tr_b16 v[234:235], v13 offset:13824
    s_waitcnt lgkmcnt(6)
    v_mfma_f32_32x32x16_bf16 v[212:227], v[236:239], v[188:191], v[212:227]
    ds_read_b64_tr_b16 v[236:237], v13 offset:14336
    ds_read_b64_tr_b16 v[238:239], v13 offset:14848
    s_waitcnt lgkmcnt(6)
    v_mfma_f32_32x32x16_bf16 v[212:227], v[240:243], v[192:195], v[212:227]
    ds_read_b64_tr_b16 v[240:241], v13 offset:15360
    ds_read_b64_tr_b16 v[242:243], v13 offset:15872
    s_waitcnt lgkmcnt(6)
    v_mfma_f32_32x32x16_bf16 v[212:227], v[228:231], v[196:199], v[212:227]
    ds_read_b64_tr_b16 v[228:229], v0 offset:0
    ds_read_b64_tr_b16 v[230:231], v0 offset:512
    s_waitcnt lgkmcnt(6)
    v_mfma_f32_32x32x16_bf16 v[212:227], v[232:235], v[200:203], v[212:227]
    ds_read_b64_tr_b16 v[232:233], v0 offset:1024
    ds_read_b64_tr_b16 v[234:235], v0 offset:1536
    s_waitcnt lgkmcnt(6)
    v_mfma_f32_32x32x16_bf16 v[212:227], v[236:239], v[204:207], v[212:227]
    ds_read_b64_tr_b16 v[236:237], v0 offset:2048
    ds_read_b64_tr_b16 v[238:239], v0 offset:2560
    s_waitcnt lgkmcnt(6)
    v_mfma_f32_32x32x16_bf16 v[212:227], v[240:243], v[208:211], v[212:227]
    ds_read_b64_tr_b16 v[240:241], v0 offset:3072
    ds_read_b64_tr_b16 v[242:243], v0 offset:3584
    s_waitcnt lgkmcnt(6)
    v_mfma_f32_32x32x16_bf16 v[148:163], v[228:231], v[20:23], 0
    ds_read_b64_tr_b16 v[228:229], v0 offset:4096
    ds_read_b64_tr_b16 v[230:231], v0 offset:4608
    s_waitcnt lgkmcnt(6)
    v_mfma_f32_32x32x16_bf16 v[148:163], v[232:235], v[24:27], v[148:163]
    ds_read_b64_tr_b16 v[232:233], v0 offset:5120
    ds_read_b64_tr_b16 v[234:235], v0 offset:5632
    s_waitcnt lgkmcnt(6)
    v_mfma_f32_32x32x16_bf16 v[148:163], v[236:239], v[28:31], v[148:163]
    ds_read_b64_tr_b16 v[236:237], v0 offset:6144
    ds_read_b64_tr_b16 v[238:239], v0 offset:6656
    s_waitcnt lgkmcnt(6)
    v_mfma_f32_32x32x16_bf16 v[148:163], v[240:243], v[32:35], v[148:163]
    ds_read_b64_tr_b16 v[240:241], v0 offset:7168
    ds_read_b64_tr_b16 v[242:243], v0 offset:7680
    s_waitcnt lgkmcnt(6)
    v_mfma_f32_32x32x16_bf16 v[148:163], v[228:231], v[36:39], v[148:163]
    ds_read_b64_tr_b16 v[228:229], v0 offset:8192
    ds_read_b64_tr_b16 v[230:231], v0 offset:8704
    s_waitcnt lgkmcnt(6)
    v_mfma_f32_32x32x16_bf16 v[148:163], v[232:235], v[40:43], v[148:163]
    ds_read_b64_tr_b16 v[232:233], v0 offset:9216
    ds_read_b64_tr_b16 v[234:235], v0 offset:9728
    s_waitcnt lgkmcnt(6)
    v_mfma_f32_32x32x16_bf16 v[148:163], v[236:239], v[44:47], v[148:163]
    ds_read_b64_tr_b16 v[236:237], v0 offset:10240
    ds_read_b64_tr_b16 v[238:239], v0 offset:10752
    s_waitcnt lgkmcnt(6)
    v_mfma_f32_32x32x16_bf16 v[148:163], v[240:243], v[48:51], v[148:163]
    ds_read_b64_tr_b16 v[240:241], v0 offset:11264
    ds_read_b64_tr_b16 v[242:243], v0 offset:11776
    s_waitcnt lgkmcnt(6)
    v_mfma_f32_32x32x16_bf16 v[148:163], v[228:231], v[52:55], v[148:163]
    ds_read_b64_tr_b16 v[228:229], v0 offset:12288
    ds_read_b64_tr_b16 v[230:231], v0 offset:12800
    s_waitcnt lgkmcnt(6)
    v_mfma_f32_32x32x16_bf16 v[148:163], v[232:235], v[56:59], v[148:163]
    ds_read_b64_tr_b16 v[232:233], v0 offset:13312
    ds_read_b64_tr_b16 v[234:235], v0 offset:13824
    s_waitcnt lgkmcnt(6)
    v_mfma_f32_32x32x16_bf16 v[148:163], v[236:239], v[60:63], v[148:163]
    ds_read_b64_tr_b16 v[236:237], v0 offset:14336
    ds_read_b64_tr_b16 v[238:239], v0 offset:14848
    s_waitcnt lgkmcnt(6)
    v_mfma_f32_32x32x16_bf16 v[148:163], v[240:243], v[64:67], v[148:163]
    ds_read_b64_tr_b16 v[240:241], v0 offset:15360
    ds_read_b64_tr_b16 v[242:243], v0 offset:15872
    s_waitcnt lgkmcnt(6)
    v_mfma_f32_32x32x16_bf16 v[148:163], v[228:231], v[68:71], v[148:163]
    ds_read_b64_tr_b16 v[228:229], v0 offset:16384
    ds_read_b64_tr_b16 v[230:231], v0 offset:16896
    s_waitcnt lgkmcnt(6)
    v_mfma_f32_32x32x16_bf16 v[148:163], v[232:235], v[72:75], v[148:163]
    ds_read_b64_tr_b16 v[232:233], v0 offset:17408
    ds_read_b64_tr_b16 v[234:235], v0 offset:17920
    s_waitcnt lgkmcnt(6)
    v_mfma_f32_32x32x16_bf16 v[148:163], v[236:239], v[76:79], v[148:163]
    ds_read_b64_tr_b16 v[236:237], v0 offset:18432
    ds_read_b64_tr_b16 v[238:239], v0 offset:18944
    s_waitcnt lgkmcnt(6)
    v_mfma_f32_32x32x16_bf16 v[148:163], v[240:243], v[80:83], v[148:163]
    ds_read_b64_tr_b16 v[240:241], v0 offset:19456
    ds_read_b64_tr_b16 v[242:243], v0 offset:19968
    s_waitcnt lgkmcnt(6)
    v_mfma_f32_32x32x16_bf16 v[148:163], v[228:231], v[84:87], v[148:163]
    ds_read_b64_tr_b16 v[228:229], v0 offset:20480
    ds_read_b64_tr_b16 v[230:231], v0 offset:20992
    s_waitcnt lgkmcnt(6)
    v_mfma_f32_32x32x16_bf16 v[148:163], v[232:235], v[88:91], v[148:163]
    ds_read_b64_tr_b16 v[232:233], v0 offset:21504
    ds_read_b64_tr_b16 v[234:235], v0 offset:22016
    s_waitcnt lgkmcnt(6)
    v_mfma_f32_32x32x16_bf16 v[148:163], v[236:239], v[92:95], v[148:163]
    ds_read_b64_tr_b16 v[236:237], v0 offset:22528
    ds_read_b64_tr_b16 v[238:239], v0 offset:23040
    s_waitcnt lgkmcnt(6)
    v_mfma_f32_32x32x16_bf16 v[148:163], v[240:243], v[96:99], v[148:163]
    ds_read_b64_tr_b16 v[240:241], v0 offset:23552
    ds_read_b64_tr_b16 v[242:243], v0 offset:24064
    s_waitcnt lgkmcnt(6)
    v_mfma_f32_32x32x16_bf16 v[148:163], v[228:231], v[100:103], v[148:163]
    ds_read_b64_tr_b16 v[228:229], v0 offset:24576
    ds_read_b64_tr_b16 v[230:231], v0 offset:25088
    s_waitcnt lgkmcnt(6)
    v_mfma_f32_32x32x16_bf16 v[148:163], v[232:235], v[104:107], v[148:163]
    ds_read_b64_tr_b16 v[232:233], v0 offset:25600
    ds_read_b64_tr_b16 v[234:235], v0 offset:26112
    s_waitcnt lgkmcnt(6)
    v_mfma_f32_32x32x16_bf16 v[148:163], v[236:239], v[108:111], v[148:163]
    ds_read_b64_tr_b16 v[236:237], v0 offset:26624
    ds_read_b64_tr_b16 v[238:239], v0 offset:27136
    s_waitcnt lgkmcnt(6)
    v_mfma_f32_32x32x16_bf16 v[148:163], v[240:243], v[112:115], v[148:163]
    ds_read_b64_tr_b16 v[240:241], v0 offset:27648
    ds_read_b64_tr_b16 v[242:243], v0 offset:28160
    s_waitcnt lgkmcnt(6)
    v_mfma_f32_32x32x16_bf16 v[148:163], v[228:231], v[116:119], v[148:163]
    ds_read_b64_tr_b16 v[228:229], v0 offset:28672
    ds_read_b64_tr_b16 v[230:231], v0 offset:29184
    s_waitcnt lgkmcnt(6)
    v_mfma_f32_32x32x16_bf16 v[148:163], v[232:235], v[120:123], v[148:163]
    ds_read_b64_tr_b16 v[232:233], v0 offset:29696
    ds_read_b64_tr_b16 v[234:235], v0 offset:30208
    s_waitcnt lgkmcnt(6)
    v_mfma_f32_32x32x16_bf16 v[148:163], v[236:239], v[124:127], v[148:163]
    ds_read_b64_tr_b16 v[236:237], v0 offset:30720
    ds_read_b64_tr_b16 v[238:239], v0 offset:31232
    s_waitcnt lgkmcnt(6)
    v_mfma_f32_32x32x16_bf16 v[148:163], v[240:243], v[128:131], v[148:163]
    ds_read_b64_tr_b16 v[240:241], v0 offset:31744
    ds_read_b64_tr_b16 v[242:243], v0 offset:32256
    s_waitcnt lgkmcnt(6)
    v_mfma_f32_32x32x16_bf16 v[148:163], v[228:231], v[132:135], v[148:163]
    s_waitcnt lgkmcnt(4)
    v_mfma_f32_32x32x16_bf16 v[148:163], v[232:235], v[136:139], v[148:163]
    s_waitcnt lgkmcnt(2)
    v_mfma_f32_32x32x16_bf16 v[148:163], v[236:239], v[140:143], v[148:163]
    s_waitcnt lgkmcnt(0)
    v_mfma_f32_32x32x16_bf16 v[148:163], v[240:243], v[144:147], v[148:163]
    ds_write_b128 v8, v[212:215] offset:0
    ds_write_b128 v8, v[216:219] offset:32
    ds_write_b128 v8, v[220:223] offset:64
    ds_write_b128 v8, v[224:227] offset:96
    s_nop 7
    v_mul_f32 v148, v148, v245
    v_mul_f32 v149, v149, v245
    v_mul_f32 v150, v150, v245
    v_mul_f32 v151, v151, v245
    ds_write_b128 v8, v[148:151] offset:36864
    v_mul_f32 v152, v152, v245
    v_mul_f32 v153, v153, v245
    v_mul_f32 v154, v154, v245
    v_mul_f32 v155, v155, v245
    ds_write_b128 v8, v[152:155] offset:36896
    v_mul_f32 v156, v156, v245
    v_mul_f32 v157, v157, v245
    v_mul_f32 v158, v158, v245
    v_mul_f32 v159, v159, v245
    ds_write_b128 v8, v[156:159] offset:36928
    v_mul_f32 v160, v160, v245
    v_mul_f32 v161, v161, v245
    v_mul_f32 v162, v162, v245
    v_mul_f32 v163, v163, v245
    ds_write_b128 v8, v[160:163] offset:36960
    v_add_u32 v7, 36864, v9
    s_branch L_tail
L_Y:
    v_and_b32 v3, 31, v1
    v_cmp_eq_u32 s[78:79], 16, v3
    v_mov_b32 v3, 0x3f803f80
    s_nop 0
    v_cndmask_b32 v148, 0, v3, s[78:79]
    v_mov_b32 v149, v148
    v_pk_mov_b32 v[150:151], v[148:149], v[148:149]
    v_pk_mov_b32 v[152:153], v[148:149], v[148:149]
    v_pk_mov_b32 v[154:155], v[148:149], v[148:149]
    v_pk_mov_b32 v[156:157], v[148:149], v[148:149]
    v_pk_mov_b32 v[158:159], v[148:149], v[148:149]
    v_pk_mov_b32 v[160:161], v[148:149], v[148:149]
    v_pk_mov_b32 v[162:163], v[148:149], v[148:149]
    v_pk_mov_b32 v[164:165], v[148:149], v[148:149]
    v_pk_mov_b32 v[166:167], v[148:149], v[148:149]
    v_pk_mov_b32 v[168:169], v[148:149], v[148:149]
    v_pk_mov_b32 v[170:171], v[148:149], v[148:149]
    v_pk_mov_b32 v[172:173], v[148:149], v[148:149]
    v_pk_mov_b32 v[174:175], v[148:149], v[148:149]
    v_pk_mov_b32 v[176:177], v[148:149], v[148:149]
    v_pk_mov_b32 v[178:179], v[148:149], v[148:149]
    v_pk_mov_b32 v[180:181], v[148:149], v[148:149]
    v_pk_mov_b32 v[182:183], v[148:149], v[148:149]
    v_pk_mov_b32 v[184:185], v[148:149], v[148:149]
    v_pk_mov_b32 v[186:187], v[148:149], v[148:149]
    v_pk_mov_b32 v[188:189], v[148:149], v[148:149]
    v_pk_mov_b32 v[190:191], v[148:149], v[148:149]
    v_pk_mov_b32 v[192:193], v[148:149], v[148:149]
    v_pk_mov_b32 v[194:195], v[148:149], v[148:149]
    v_pk_mov_b32 v[196:197], v[148:149], v[148:149]
    v_pk_mov_b32 v[198:199], v[148:149], v[148:149]
    v_pk_mov_b32 v[200:201], v[148:149], v[148:149]
    v_pk_mov_b32 v[202:203], v[148:149], v[148:149]
    v_pk_mov_b32 v[204:205], v[148:149], v[148:149]
    v_pk_mov_b32 v[206:207], v[148:149], v[148:149]
    v_pk_mov_b32 v[208:209], v[148:149], v[148:149]
    v_pk_mov_b32 v[210:211], v[148:149], v[148:149]
    v_lshrrev_b32 v3, 1, v17
    v_xor_b32 v3, v3, v17
    v_and_b32 v3, 64, v3
    v_mul_u32_u24 v3, 3, v3
    v_xor_b32 v18, v3, v17
    v_mov_b32 v19, 0xdddddddd
    s_lshl_b32 s79, s74, 16
    s_lshl_b32 s80, s75, 13
    s_add_u32 s18, s79, s80
    s_add_u32 s18, s18, 1048576
    s_add_u32 s19, s18, 4096
    s_lshl_b32 s80, s68, 13
    s_add_u32 s79, s79, s80
    s_add_u32 s84, s79, 3145728
    s_add_u32 s86, s79, 5242880
    s_add_u32 s85, s84, 4096
    s_add_u32 s87, s86, 4096
    s_waitcnt lgkmcnt(0)
    s_barrier
    s_lshl_b32 s78, s16, 14
    s_add_u32 s78, s78, 98304
    v_add_u32 v3, s78, v17
    s_cmp_eq_u32 s70, 0
    s_cbranch_scc1 L_Yphi
    ds_read_b128 v[20:23], v3 offset:0
    ds_read_b128 v[24:27], v3 offset:1024
    ds_read_b128 v[28:31], v3 offset:2048
    ds_read_b128 v[32:35], v3 offset:3072
    ds_read_b128 v[36:39], v3 offset:4096
    ds_read_b128 v[40:43], v3 offset:5120
    ds_read_b128 v[44:47], v3 offset:6144
    ds_read_b128 v[48:51], v3 offset:7168
    ds_read_b128 v[52:55], v3 offset:8192
    ds_read_b128 v[56:59], v3 offset:9216
    ds_read_b128 v[60:63], v3 offset:10240
    ds_read_b128 v[64:67], v3 offset:11264
    s_waitcnt lgkmcnt(8)
    ds_read_b128 v[68:71], v3 offset:12288
    ds_read_b128 v[72:75], v3 offset:13312
    ds_read_b128 v[76:79], v3 offset:14336
    ds_read_b128 v[80:83], v3 offset:15360
    s_lshl_b32 s78, s69, 2
    s_add_u32 s78, s78, s16
    s_lshl_b32 s78, s78, 4
    s_add_u32 s78, s78, s71
    s_lshl_b32 s80, s78, 12
    s_add_u32 s80, s80, 11534336
    s_lshl_b32 s78, s78, 3
    s_add_u32 s78, s78, 28672
    s_waitcnt lgkmcnt(0)
    v_add_f32 v20, v20, v52
    v_add_f32 v21, v21, v53
    v_add_f32 v22, v22, v54
    v_add_f32 v23, v23, v55
    v_add_f32 v24, v24, v56
    v_add_f32 v25, v25, v57
    v_add_f32 v26, v26, v58
    v_add_f32 v27, v27, v59
    v_add_f32 v28, v28, v60
    v_add_f32 v29, v29, v61
    v_add_f32 v30, v30, v62
    v_add_f32 v31, v31, v63
    v_add_f32 v32, v32, v64
    v_add_f32 v33, v33, v65
    v_add_f32 v34, v34, v66
    v_add_f32 v35, v35, v67
    v_add_f32 v36, v36, v68
    v_add_f32 v37, v37, v69
    v_add_f32 v38, v38, v70
    v_add_f32 v39, v39, v71
    v_add_f32 v40, v40, v72
    v_add_f32 v41, v41, v73
    v_add_f32 v42, v42, v74
    v_add_f32 v43, v43, v75
    v_add_f32 v44, v44, v76
    v_add_f32 v45, v45, v77
    v_add_f32 v46, v46, v78
    v_add_f32 v47, v47, v79
    v_add_f32 v48, v48, v80
    v_add_f32 v49, v49, v81
    v_add_f32 v50, v50, v82
    v_add_f32 v51, v51, v83
    v_add_f32 v20, v20, v36
    v_add_f32 v21, v21, v37
    v_add_f32 v22, v22, v38
    v_add_f32 v23, v23, v39
    v_add_f32 v24, v24, v40
    v_add_f32 v25, v25, v41
    v_add_f32 v26, v26, v42
    v_add_f32 v27, v27, v43
    v_add_f32 v28, v28, v44
    v_add_f32 v29, v29, v45
    v_add_f32 v30, v30, v46
    v_add_f32 v31, v31, v47
    v_add_f32 v32, v32, v48
    v_add_f32 v33, v33, v49
    v_add_f32 v34, v34, v50
    v_add_f32 v35, v35, v51
    buffer_store_dwordx4 v[20:23], v17, s[44:47], s80 offen sc1
    buffer_store_dwordx4 v[24:27], v17, s[44:47], s80 offen offset:1024 sc1
    buffer_store_dwordx4 v[28:31], v17, s[44:47], s80 offen offset:2048 sc1
    buffer_store_dwordx4 v[32:35], v17, s[44:47], s80 offen offset:3072 sc1
    s_branch L_Ypub
L_Yphi:
    ds_read_b128 v[20:23], v3 offset:0
    ds_read_b128 v[24:27], v3 offset:1024
    ds_read_b128 v[28:31], v3 offset:2048
    ds_read_b128 v[32:35], v3 offset:3072
    ds_read_b128 v[36:39], v3 offset:4096
    ds_read_b128 v[40:43], v3 offset:5120
    ds_read_b128 v[44:47], v3 offset:6144
    ds_read_b128 v[48:51], v3 offset:7168
    s_lshl_b32 s79, s69, 19
    s_lshl_b32 s80, s76, 11
    s_add_u32 s79, s79, s80
    s_add_u32 s79, s79, 7340032
    s_lshl_b32 s78, s69, 6
    s_add_u32 s78, s78, s76
    s_lshl_b32 s78, s78, 3
    s_add_u32 s78, s78, 20480
    s_waitcnt lgkmcnt(0)
    buffer_store_dwordx4 v[20:23], v17, s[44:47], s79 offen sc1
    buffer_store_dwordx4 v[24:27], v17, s[44:47], s79 offen offset:1024 sc1
    s_add_u32 s79, s79, 131072
    buffer_store_dwordx4 v[28:31], v17, s[44:47], s79 offen sc1
    buffer_store_dwordx4 v[32:35], v17, s[44:47], s79 offen offset:1024 sc1
    s_add_u32 s79, s79, 131072
    buffer_store_dwordx4 v[36:39], v17, s[44:47], s79 offen sc1
    buffer_store_dwordx4 v[40:43], v17, s[44:47], s79 offen offset:1024 sc1
    s_add_u32 s79, s79, 131072
    buffer_store_dwordx4 v[44:47], v17, s[44:47], s79 offen sc1
    buffer_store_dwordx4 v[48:51], v17, s[44:47], s79 offen offset:1024 sc1
    s_add_u32 s79, s79, 131072
L_Ypub:
    s_lshl_b32 s3, s78, 3
    s_add_u32 s3, s3, 19922944
    s_waitcnt vmcnt(0)
    s_mov_b64 exec, 1
    buffer_store_dwordx2 v[250:251], v252, s[44:47], s3 offen sc1
    s_mov_b64 exec, -1
    s_mov_b32 s3, 19922944
    s_mov_b32 s88, 0x100000
    v_lshlrev_b32 v253, 3, v253
L_poll10:
    buffer_load_dwordx2 v[248:249], v253, s[44:47], s3 offen sc1
    s_waitcnt vmcnt(0)
    v_cmp_ne_u64 vcc, s[26:27], v[248:249]
    s_cmp_eq_u64 vcc, 0
    s_cbranch_scc1 L_polld10
    s_sub_u32 s88, s88, 1
    s_cmp_eq_u32 s88, 0
    s_cbranch_scc1 L_polld10
    s_sleep 1
    s_branch L_poll10
L_polld10:
    buffer_load_dwordx4 v[212:215], v17, s[44:47], s18 offen offset:0 sc1
    buffer_load_dwordx4 v[116:119], v18, s[44:47], s84 offen offset:0 sc1
    s_mov_b64 exec, s[4:5]
    buffer_load_dwordx4 v[148:151], v255, s[44:47], s86 offen offset:0 sc1
    buffer_load_dwordx4 v[152:155], v255, s[44:47], s86 offen offset:512 sc1
    s_mov_b64 exec, -1
    buffer_load_dwordx4 v[120:123], v18, s[44:47], s84 offen offset:1024 sc1
    s_mov_b64 exec, s[4:5]
    buffer_load_dwordx4 v[156:159], v255, s[44:47], s86 offen offset:1024 sc1
    buffer_load_dwordx4 v[160:163], v255, s[44:47], s86 offen offset:1536 sc1
    s_mov_b64 exec, -1
    buffer_load_dwordx4 v[124:127], v18, s[44:47], s84 offen offset:2048 sc1
    s_mov_b64 exec, s[4:5]
    buffer_load_dwordx4 v[164:167], v255, s[44:47], s86 offen offset:2048 sc1
    buffer_load_dwordx4 v[168:171], v255, s[44:47], s86 offen offset:2560 sc1
    s_mov_b64 exec, -1
    buffer_load_dwordx4 v[128:131], v18, s[44:47], s84 offen offset:3072 sc1
    s_mov_b64 exec, s[4:5]
    buffer_load_dwordx4 v[172:175], v255, s[44:47], s86 offen offset:3072 sc1
    buffer_load_dwordx4 v[176:179], v255, s[44:47], s86 offen offset:3584 sc1
    s_mov_b64 exec, -1
    buffer_load_dwordx4 v[132:135], v18, s[44:47], s85 offen offset:0 sc1
    s_mov_b64 exec, s[4:5]
    buffer_load_dwordx4 v[180:183], v255, s[44:47], s87 offen offset:0 sc1
    buffer_load_dwordx4 v[184:187], v255, s[44:47], s87 offen offset:512 sc1
    s_mov_b64 exec, -1
    buffer_load_dwordx4 v[136:139], v18, s[44:47], s85 offen offset:1024 sc1
    s_mov_b64 exec, s[4:5]
    buffer_load_dwordx4 v[188:191], v255, s[44:47], s87 offen offset:1024 sc1
    buffer_load_dwordx4 v[192:195], v255, s[44:47], s87 offen offset:1536 sc1
    s_mov_b64 exec, -1
    buffer_load_dwordx4 v[140:143], v18, s[44:47], s85 offen offset:2048 sc1
    s_mov_b64 exec, s[4:5]
    buffer_load_dwordx4 v[196:199], v255, s[44:47], s87 offen offset:2048 sc1
    buffer_load_dwordx4 v[200:203], v255, s[44:47], s87 offen offset:2560 sc1
    s_mov_b64 exec, -1
    buffer_load_dwordx4 v[144:147], v18, s[44:47], s85 offen offset:3072 sc1
    s_mov_b64 exec, s[4:5]
    buffer_load_dwordx4 v[204:207], v255, s[44:47], s87 offen offset:3072 sc1
    buffer_load_dwordx4 v[208:211], v255, s[44:47], s87 offen offset:3584 sc1
    s_mov_b64 exec, -1
    buffer_load_dwordx4 v[216:219], v17, s[44:47], s18 offen offset:1024 sc1
    buffer_load_dwordx4 v[220:223], v17, s[44:47], s18 offen offset:2048 sc1
    buffer_load_dwordx4 v[224:227], v17, s[44:47], s18 offen offset:3072 sc1
    buffer_load_dwordx4 v[228:231], v17, s[44:47], s19 offen offset:0 sc1
    buffer_load_dwordx4 v[232:235], v17, s[44:47], s19 offen offset:1024 sc1
    buffer_load_dwordx4 v[236:239], v17, s[44:47], s19 offen offset:2048 sc1
    buffer_load_dwordx4 v[240:243], v17, s[44:47], s19 offen offset:3072 sc1
    s_lshl_b32 s78, s74, 7
    s_add_u32 s78, s78, 28672
    v_lshlrev_b32 v2, 3, v1
    v_add_u32 v2, s78, v2
    s_lshl_b32 s76, s75, 3
    s_lshl_b32 s78, s16, 1
    s_add_u32 s76, s76, s78
    s_lshl_b32 s78, s89, 6
    s_add_u32 s78, s78, s76
    s_lshl_b32 s78, s78, 3
    s_add_u32 s78, s78, 20480
    v_and_b32 v3, 1, v1
    v_lshl_add_u32 v3, v3, 3, s78
    v_cmp_gt_u32 s[78:79], 16, v1
    s_nop 1
    v_cndmask_b32 v253, v3, v2, s[78:79]
    s_mov_b32 s3, 19922944
    s_mov_b32 s88, 0x100000
    v_lshlrev_b32 v253, 3, v253
L_poll11:
    buffer_load_dwordx2 v[248:249], v253, s[44:47], s3 offen sc1
    s_waitcnt vmcnt(0)
    v_cmp_ne_u64 vcc, s[26:27], v[248:249]
    s_cmp_eq_u64 vcc, 0
    s_cbranch_scc1 L_polld11
    s_sub_u32 s88, s88, 1
    s_cmp_eq_u32 s88, 0
    s_cbranch_scc1 L_polld11
    s_sleep 1
    s_branch L_poll11
L_polld11:
    s_lshl_b32 s78, s74, 16
    s_lshl_b32 s79, s16, 10
    s_add_u32 s78, s78, s79
    s_add_u32 s78, s78, 11534336
    buffer_load_dwordx4 v[52:55], v17, s[44:47], s78 offen sc1
    s_add_u32 s78, s78, 4096
    buffer_load_dwordx4 v[56:59], v17, s[44:47], s78 offen sc1
    s_add_u32 s78, s78, 4096
    buffer_load_dwordx4 v[60:63], v17, s[44:47], s78 offen sc1
    s_add_u32 s78, s78, 4096
    buffer_load_dwordx4 v[64:67], v17, s[44:47], s78 offen sc1
    s_add_u32 s78, s78, 4096
    buffer_load_dwordx4 v[68:71], v17, s[44:47], s78 offen sc1
    s_add_u32 s78, s78, 4096
    buffer_load_dwordx4 v[72:75], v17, s[44:47], s78 offen sc1
    s_add_u32 s78, s78, 4096
    buffer_load_dwordx4 v[76:79], v17, s[44:47], s78 offen sc1
    s_add_u32 s78, s78, 4096
    buffer_load_dwordx4 v[80:83], v17, s[44:47], s78 offen sc1
    s_add_u32 s78, s78, 4096
    buffer_load_dwordx4 v[84:87], v17, s[44:47], s78 offen sc1
    s_add_u32 s78, s78, 4096
    buffer_load_dwordx4 v[88:91], v17, s[44:47], s78 offen sc1
    s_add_u32 s78, s78, 4096
    buffer_load_dwordx4 v[92:95], v17, s[44:47], s78 offen sc1
    s_add_u32 s78, s78, 4096
    buffer_load_dwordx4 v[96:99], v17, s[44:47], s78 offen sc1
    s_add_u32 s78, s78, 4096
    buffer_load_dwordx4 v[100:103], v17, s[44:47], s78 offen sc1
    s_add_u32 s78, s78, 4096
    buffer_load_dwordx4 v[104:107], v17, s[44:47], s78 offen sc1
    s_add_u32 s78, s78, 4096
    buffer_load_dwordx4 v[108:111], v17, s[44:47], s78 offen sc1
    s_add_u32 s78, s78, 4096
    buffer_load_dwordx4 v[112:115], v17, s[44:47], s78 offen sc1
    v_mfma_f32_32x32x16_bf16 v[20:35], v[116:119], v[212:215], 0
    s_lshl_b32 s79, s75, 3
    s_add_u32 s79, s79, s68
    s_lshl_b32 s79, s79, 5
    s_add_u32 s79, s79, s74
    s_lshl_b32 s79, s79, 10
    s_add_u32 s79, s79, 13631488
    v_mov_b32 v40, -1
    v_mov_b32 v41, -1
    v_mov_b32 v42, -1
    v_mov_b32 v43, -1
    buffer_store_dwordx4 v[40:43], v17, s[44:47], s79 offen sc1
    s_add_u32 s14, s14, 4
    s_lshr_b32 s73, s16, 1
    s_lshl_b32 s78, s73, 14
    s_add_u32 s78, s78, 32768
    v_add_u32 v13, s78, v0
    s_lshl_b32 s72, s14, 5
    s_lshl_b32 s78, s73, 4
    s_add_u32 s72, s72, s78
    s_lshl_b32 s78, s72, 3
    s_add_u32 s78, s78, 36864
    v_and_b32 v2, 15, v1
    v_lshl_add_u32 v15, v2, 3, s78
    s_lshl_b32 s72, s72, 10
    s_add_u32 s72, s72, 13631488
    s_lshl_b32 s77, s14, 15
    s_add_u32 s77, s77, s15
    s_lshl_b32 s78, s73, 14
    s_add_u32 s77, s77, s78
    v_and_b32 v2, 31, v1
    v_lshlrev_b32 v14, 2, v2
    s_mul_i32 s78, s68, 4608
    v_add_u32 v8, s78, v246
    v_lshrrev_b32 v2, 2, v1
    v_and_b32 v3, 3, v1
    v_lshlrev_b32 v10, 10, v2
    v_lshl_add_u32 v10, v3, 4, v10
    s_lshl_b32 s78, s73, 4
    v_add_u32 v2, s78, v2
    v_lshlrev_b32 v16, 2, v2
    v_mul_u32_u24 v2, 144, v2
    v_lshl_add_u32 v2, v3, 5, v2
    s_and_b32 s78, s68, 5
    s_mul_i32 s78, s78, 4608
    v_add_u32 v9, s78, v2
    s_mul_i32 s78, s68, 9216
    s_add_u32 s78, s78, 24576
    v_add_u32 v11, s78, v17
    v_add_u32 v12, s78, v14
    s_lshl_b32 s17, s75, 3
    s_add_u32 s17, s17, s68
    s_lshl_b32 s23, s17, 5
    s_add_u32 s23, s23, s74
    s_lshl_b32 s22, s23, 3
    s_add_u32 s22, s22, 36864
    s_lshl_b32 s23, s23, 10
    s_add_u32 s23, s23, 13631488
    s_mov_b32 s21, 0x53800000
    s_lshr_b32 s78, s16, 1
    s_lshl_b32 s78, s78, 10
    s_and_b32 s79, s16, 1
    s_lshl_b32 s79, s79, 3
    s_add_u32 s78, s78, s79
    v_add_u32 v2, s78, v17
    s_waitcnt vmcnt(1)
    v_add_f32 v52, v52, v84
    v_add_f32 v53, v53, v85
    v_add_f32 v54, v54, v86
    v_add_f32 v55, v55, v87
    v_add_f32 v56, v56, v88
    v_add_f32 v57, v57, v89
    v_add_f32 v58, v58, v90
    v_add_f32 v59, v59, v91
    v_add_f32 v60, v60, v92
    v_add_f32 v61, v61, v93
    v_add_f32 v62, v62, v94
    v_add_f32 v63, v63, v95
    v_add_f32 v64, v64, v96
    v_add_f32 v65, v65, v97
    v_add_f32 v66, v66, v98
    v_add_f32 v67, v67, v99
    v_add_f32 v68, v68, v100
    v_add_f32 v69, v69, v101
    v_add_f32 v70, v70, v102
    v_add_f32 v71, v71, v103
    v_add_f32 v72, v72, v104
    v_add_f32 v73, v73, v105
    v_add_f32 v74, v74, v106
    v_add_f32 v75, v75, v107
    v_add_f32 v76, v76, v108
    v_add_f32 v77, v77, v109
    v_add_f32 v78, v78, v110
    v_add_f32 v79, v79, v111
    v_add_f32 v80, v80, v112
    v_add_f32 v81, v81, v113
    v_add_f32 v82, v82, v114
    v_add_f32 v83, v83, v115
    v_add_f32 v52, v52, v68
    v_add_f32 v53, v53, v69
    v_add_f32 v54, v54, v70
    v_add_f32 v55, v55, v71
    v_add_f32 v56, v56, v72
    v_add_f32 v57, v57, v73
    v_add_f32 v58, v58, v74
    v_add_f32 v59, v59, v75
    v_add_f32 v60, v60, v76
    v_add_f32 v61, v61, v77
    v_add_f32 v62, v62, v78
    v_add_f32 v63, v63, v79
    v_add_f32 v64, v64, v80
    v_add_f32 v65, v65, v81
    v_add_f32 v66, v66, v82
    v_add_f32 v67, v67, v83
    v_add_f32 v52, v52, v60
    v_add_f32 v53, v53, v61
    v_add_f32 v54, v54, v62
    v_add_f32 v55, v55, v63
    v_add_f32 v56, v56, v64
    v_add_f32 v57, v57, v65
    v_add_f32 v58, v58, v66
    v_add_f32 v59, v59, v67
    v_add_f32 v52, v52, v56
    v_add_f32 v53, v53, v57
    v_add_f32 v54, v54, v58
    v_add_f32 v55, v55, v59
    v_cvt_pk_bf16_f32 v56, v52, v53
    v_cvt_pk_bf16_f32 v57, v54, v55
    ds_write_b64 v2, v[56:57] offset:8192
    s_lshl_b32 s76, s14, 7
    s_add_u32 s76, s76, 131072
    s_add_u32 s84, s72, 4096
    s_add_u32 s85, s72, 8192
    s_add_u32 s86, s72, 12288
    s_waitcnt vmcnt(0) lgkmcnt(0)
    v_lshrrev_b32 v2, 2, v1
    v_and_b32 v3, 3, v1
    v_lshlrev_b32 v3, 4, v3
    v_lshl_add_u32 v3, v2, 10, v3
    s_and_b32 s78, s16, 1
    s_lshl_b32 s78, s78, 18
    s_add_u32 s78, s78, s15
    s_lshl_b32 s79, s16, 14
    s_add_u32 s79, s79, 98304
    s_mov_b32 s80, 8
L_wo0:
    s_mov_b32 m0, s79
    s_add_u32 s79, s79, 1024
    buffer_load_dwordx4 v3, s[40:43], s78 offen lds
    s_add_u32 s78, s78, 16384
    s_sub_u32 s80, s80, 1
    s_cmp_lg_u32 s80, 0
    s_cbranch_scc1 L_wo0
    s_setprio 0
    s_barrier
    ds_read_b128 v[52:55], v4 offset:0
    ds_read_b128 v[56:59], v5 offset:0
    ds_read_b32 v60, v6 offset:0
    ds_read_b128 v[62:65], v4 offset:9216
    ds_read_b128 v[66:69], v5 offset:9216
    ds_read_b32 v70, v6 offset:9216
    ds_read_b128 v[72:75], v4 offset:18432
    ds_read_b128 v[76:79], v5 offset:18432
    ds_read_b32 v80, v6 offset:18432
    ds_read_b128 v[82:85], v4 offset:27648
    ds_read_b128 v[86:89], v5 offset:27648
    ds_read_b32 v90, v6 offset:27648
    ds_read_b128 v[92:95], v4 offset:36864
    ds_read_b128 v[96:99], v5 offset:36864
    ds_read_b32 v100, v6 offset:36864
    .p2align 3
    v_exp_f32 v20, v20
    v_exp_f32 v21, v21
    v_exp_f32 v22, v22
    v_exp_f32 v23, v23
    v_exp_f32 v24, v24
    v_mfma_f32_32x32x16_bf16 v[36:51], v[120:123], v[212:215], 0
    s_waitcnt lgkmcnt(0)
    v_exp_f32 v25, v25
    v_exp_f32 v26, v26
    v_exp_f32 v27, v27
    v_exp_f32 v28, v28
    v_exp_f32 v29, v29
    v_exp_f32 v30, v30
    v_smfmac_f32_32x32x32_bf16 v[52:67], v[148:151], v[20:27], v19
    v_exp_f32 v31, v31
    v_exp_f32 v32, v32
    v_exp_f32 v33, v33
    v_exp_f32 v34, v34
    v_exp_f32 v35, v35
    v_exp_f32 v36, v36
    v_exp_f32 v37, v37
    v_smfmac_f32_32x32x32_bf16 v[52:67], v[152:155], v[28:35], v19
    v_exp_f32 v38, v38
    v_exp_f32 v39, v39
    v_exp_f32 v40, v40
    v_mfma_f32_32x32x16_bf16 v[20:35], v[124:127], v[212:215], 0
    v_exp_f32 v41, v41
    v_exp_f32 v42, v42
    v_exp_f32 v43, v43
    v_exp_f32 v44, v44
    v_exp_f32 v45, v45
    v_exp_f32 v46, v46
    v_smfmac_f32_32x32x32_bf16 v[52:67], v[156:159], v[36:43], v19
    v_exp_f32 v47, v47
    v_exp_f32 v48, v48
    v_exp_f32 v49, v49
    v_exp_f32 v50, v50
    v_exp_f32 v51, v51
    v_exp_f32 v20, v20
    v_exp_f32 v21, v21
    v_smfmac_f32_32x32x32_bf16 v[52:67], v[160:163], v[44:51], v19
    v_exp_f32 v22, v22
    v_exp_f32 v23, v23
    v_exp_f32 v24, v24
    v_mfma_f32_32x32x16_bf16 v[36:51], v[128:131], v[212:215], 0
    v_exp_f32 v25, v25
    v_exp_f32 v26, v26
    v_exp_f32 v27, v27
    v_exp_f32 v28, v28
    v_exp_f32 v29, v29
    v_exp_f32 v30, v30
    v_smfmac_f32_32x32x32_bf16 v[52:67], v[164:167], v[20:27], v19
    v_exp_f32 v31, v31
    v_exp_f32 v32, v32
    v_exp_f32 v33, v33
    v_exp_f32 v34, v34
    v_exp_f32 v35, v35
    v_exp_f32 v36, v36
    v_exp_f32 v37, v37
    v_smfmac_f32_32x32x32_bf16 v[52:67], v[168:171], v[28:35], v19
    v_exp_f32 v38, v38
    v_exp_f32 v39, v39
    v_exp_f32 v40, v40
    v_mfma_f32_32x32x16_bf16 v[20:35], v[132:135], v[212:215], 0
    v_exp_f32 v41, v41
    v_exp_f32 v42, v42
    v_exp_f32 v43, v43
    v_exp_f32 v44, v44
    v_exp_f32 v45, v45
    v_exp_f32 v46, v46
    v_smfmac_f32_32x32x32_bf16 v[52:67], v[172:175], v[36:43], v19
    v_exp_f32 v47, v47
    v_exp_f32 v48, v48
    v_exp_f32 v49, v49
    v_exp_f32 v50, v50
    v_exp_f32 v51, v51
    v_exp_f32 v20, v20
    v_exp_f32 v21, v21
    v_smfmac_f32_32x32x32_bf16 v[52:67], v[176:179], v[44:51], v19
    v_exp_f32 v22, v22
    v_exp_f32 v23, v23
    v_exp_f32 v24, v24
    v_mfma_f32_32x32x16_bf16 v[36:51], v[136:139], v[212:215], 0
    v_exp_f32 v25, v25
    v_exp_f32 v26, v26
    v_exp_f32 v27, v27
    v_exp_f32 v28, v28
    v_exp_f32 v29, v29
    v_exp_f32 v30, v30
    v_smfmac_f32_32x32x32_bf16 v[52:67], v[180:183], v[20:27], v19
    v_exp_f32 v31, v31
    v_exp_f32 v32, v32
    v_exp_f32 v33, v33
    v_exp_f32 v34, v34
    v_exp_f32 v35, v35
    v_exp_f32 v36, v36
    v_exp_f32 v37, v37
    v_smfmac_f32_32x32x32_bf16 v[52:67], v[184:187], v[28:35], v19
    v_exp_f32 v38, v38
    v_exp_f32 v39, v39
    v_exp_f32 v40, v40
    v_mfma_f32_32x32x16_bf16 v[20:35], v[140:143], v[212:215], 0
    v_exp_f32 v41, v41
    v_exp_f32 v42, v42
    v_exp_f32 v43, v43
    v_exp_f32 v44, v44
    v_exp_f32 v45, v45
    v_exp_f32 v46, v46
    v_smfmac_f32_32x32x32_bf16 v[52:67], v[188:191], v[36:43], v19
    v_exp_f32 v47, v47
    v_exp_f32 v48, v48
    v_exp_f32 v49, v49
    v_exp_f32 v50, v50
    v_exp_f32 v51, v51
    v_exp_f32 v20, v20
    v_exp_f32 v21, v21
    v_smfmac_f32_32x32x32_bf16 v[52:67], v[192:195], v[44:51], v19
    v_exp_f32 v22, v22
    v_exp_f32 v23, v23
    v_exp_f32 v24, v24
    v_mfma_f32_32x32x16_bf16 v[36:51], v[144:147], v[212:215], 0
    v_exp_f32 v25, v25
    v_exp_f32 v26, v26
    v_exp_f32 v27, v27
    v_exp_f32 v28, v28
    v_exp_f32 v29, v29
    v_exp_f32 v30, v30
    v_smfmac_f32_32x32x32_bf16 v[52:67], v[196:199], v[20:27], v19
    v_exp_f32 v31, v31
    v_exp_f32 v32, v32
    v_exp_f32 v33, v33
    v_exp_f32 v34, v34
    v_exp_f32 v35, v35
    v_exp_f32 v36, v36
    v_exp_f32 v37, v37
    v_smfmac_f32_32x32x32_bf16 v[52:67], v[200:203], v[28:35], v19
    v_exp_f32 v38, v38
    v_exp_f32 v39, v39
    v_exp_f32 v40, v40
    v_mfma_f32_32x32x16_bf16 v[20:35], v[116:119], v[216:219], 0
    v_exp_f32 v41, v41
    v_exp_f32 v42, v42
    v_exp_f32 v43, v43
    v_exp_f32 v44, v44
    v_exp_f32 v45, v45
    v_exp_f32 v46, v46
    v_smfmac_f32_32x32x32_bf16 v[52:67], v[204:207], v[36:43], v19
    v_exp_f32 v47, v47
    v_exp_f32 v48, v48
    v_exp_f32 v49, v49
    v_exp_f32 v50, v50
    v_exp_f32 v51, v51
    v_exp_f32 v20, v20
    v_exp_f32 v21, v21
    v_smfmac_f32_32x32x32_bf16 v[52:67], v[208:211], v[44:51], v19
    v_exp_f32 v22, v22
    v_exp_f32 v23, v23
    v_exp_f32 v24, v24
    v_mfma_f32_32x32x16_bf16 v[36:51], v[120:123], v[216:219], 0
    v_exp_f32 v25, v25
    v_exp_f32 v26, v26
    v_exp_f32 v27, v27
    v_exp_f32 v28, v28
    v_exp_f32 v29, v29
    v_exp_f32 v30, v30
    v_smfmac_f32_32x32x32_bf16 v[62:77], v[148:151], v[20:27], v19
    v_exp_f32 v31, v31
    v_exp_f32 v32, v32
    v_exp_f32 v33, v33
    v_exp_f32 v34, v34
    v_exp_f32 v35, v35
    v_exp_f32 v36, v36
    v_exp_f32 v37, v37
    v_smfmac_f32_32x32x32_bf16 v[62:77], v[152:155], v[28:35], v19
    v_exp_f32 v38, v38
    v_exp_f32 v39, v39
    v_exp_f32 v40, v40
    v_mfma_f32_32x32x16_bf16 v[20:35], v[124:127], v[216:219], 0
    v_exp_f32 v41, v41
    v_exp_f32 v42, v42
    v_exp_f32 v43, v43
    v_exp_f32 v44, v44
    v_exp_f32 v45, v45
    v_exp_f32 v46, v46
    v_smfmac_f32_32x32x32_bf16 v[62:77], v[156:159], v[36:43], v19
    ds_write_b128 v4, v[52:55] offset:0
    v_exp_f32 v47, v47
    v_exp_f32 v48, v48
    v_exp_f32 v49, v49
    v_exp_f32 v50, v50
    v_exp_f32 v51, v51
    v_exp_f32 v20, v20
    v_exp_f32 v21, v21
    v_smfmac_f32_32x32x32_bf16 v[62:77], v[160:163], v[44:51], v19
    v_exp_f32 v22, v22
    v_exp_f32 v23, v23
    v_exp_f32 v24, v24
    v_mfma_f32_32x32x16_bf16 v[36:51], v[128:131], v[216:219], 0
    v_exp_f32 v25, v25
    v_exp_f32 v26, v26
    v_exp_f32 v27, v27
    v_exp_f32 v28, v28
    v_exp_f32 v29, v29
    v_exp_f32 v30, v30
    v_smfmac_f32_32x32x32_bf16 v[62:77], v[164:167], v[20:27], v19
    ds_write_b128 v5, v[56:59] offset:0
    v_exp_f32 v31, v31
    v_exp_f32 v32, v32
    v_exp_f32 v33, v33
    v_exp_f32 v34, v34
    v_exp_f32 v35, v35
    v_exp_f32 v36, v36
    v_exp_f32 v37, v37
    v_smfmac_f32_32x32x32_bf16 v[62:77], v[168:171], v[28:35], v19
    v_exp_f32 v38, v38
    v_exp_f32 v39, v39
    v_exp_f32 v40, v40
    v_mfma_f32_32x32x16_bf16 v[20:35], v[132:135], v[216:219], 0
    v_exp_f32 v41, v41
    v_exp_f32 v42, v42
    v_exp_f32 v43, v43
    v_exp_f32 v44, v44
    v_exp_f32 v45, v45
    v_exp_f32 v46, v46
    v_smfmac_f32_32x32x32_bf16 v[62:77], v[172:175], v[36:43], v19
    ds_write_b32 v6, v60 offset:0
    v_exp_f32 v47, v47
    v_exp_f32 v48, v48
    v_exp_f32 v49, v49
    v_exp_f32 v50, v50
    v_exp_f32 v51, v51
    v_exp_f32 v20, v20
    v_exp_f32 v21, v21
    v_smfmac_f32_32x32x32_bf16 v[62:77], v[176:179], v[44:51], v19
    v_exp_f32 v22, v22
    v_exp_f32 v23, v23
    v_exp_f32 v24, v24
    v_mfma_f32_32x32x16_bf16 v[36:51], v[136:139], v[216:219], 0
    v_exp_f32 v25, v25
    v_exp_f32 v26, v26
    v_exp_f32 v27, v27
    v_exp_f32 v28, v28
    v_exp_f32 v29, v29
    v_exp_f32 v30, v30
    v_smfmac_f32_32x32x32_bf16 v[62:77], v[180:183], v[20:27], v19
    v_exp_f32 v31, v31
    v_exp_f32 v32, v32
    v_exp_f32 v33, v33
    v_exp_f32 v34, v34
    v_exp_f32 v35, v35
    v_exp_f32 v36, v36
    v_exp_f32 v37, v37
    v_smfmac_f32_32x32x32_bf16 v[62:77], v[184:187], v[28:35], v19
    v_exp_f32 v38, v38
    v_exp_f32 v39, v39
    v_exp_f32 v40, v40
    v_mfma_f32_32x32x16_bf16 v[20:35], v[140:143], v[216:219], 0
    v_exp_f32 v41, v41
    v_exp_f32 v42, v42
    v_exp_f32 v43, v43
    v_exp_f32 v44, v44
    v_exp_f32 v45, v45
    v_exp_f32 v46, v46
    v_smfmac_f32_32x32x32_bf16 v[62:77], v[188:191], v[36:43], v19
    v_exp_f32 v47, v47
    v_exp_f32 v48, v48
    v_exp_f32 v49, v49
    v_exp_f32 v50, v50
    v_exp_f32 v51, v51
    v_exp_f32 v20, v20
    v_exp_f32 v21, v21
    v_smfmac_f32_32x32x32_bf16 v[62:77], v[192:195], v[44:51], v19
    v_exp_f32 v22, v22
    v_exp_f32 v23, v23
    v_exp_f32 v24, v24
    v_mfma_f32_32x32x16_bf16 v[36:51], v[144:147], v[216:219], 0
    v_exp_f32 v25, v25
    v_exp_f32 v26, v26
    v_exp_f32 v27, v27
    v_exp_f32 v28, v28
    v_exp_f32 v29, v29
    v_exp_f32 v30, v30
    v_smfmac_f32_32x32x32_bf16 v[62:77], v[196:199], v[20:27], v19
    v_exp_f32 v31, v31
    v_exp_f32 v32, v32
    v_exp_f32 v33, v33
    v_exp_f32 v34, v34
    v_exp_f32 v35, v35
    v_exp_f32 v36, v36
    v_exp_f32 v37, v37
    v_smfmac_f32_32x32x32_bf16 v[62:77], v[200:203], v[28:35], v19
    v_exp_f32 v38, v38
    v_exp_f32 v39, v39
    v_exp_f32 v40, v40
    v_mfma_f32_32x32x16_bf16 v[20:35], v[116:119], v[220:223], 0
    v_exp_f32 v41, v41
    v_exp_f32 v42, v42
    v_exp_f32 v43, v43
    v_exp_f32 v44, v44
    v_exp_f32 v45, v45
    v_exp_f32 v46, v46
    v_smfmac_f32_32x32x32_bf16 v[62:77], v[204:207], v[36:43], v19
    v_exp_f32 v47, v47
    v_exp_f32 v48, v48
    v_exp_f32 v49, v49
    v_exp_f32 v50, v50
    v_exp_f32 v51, v51
    v_exp_f32 v20, v20
    v_exp_f32 v21, v21
    v_smfmac_f32_32x32x32_bf16 v[62:77], v[208:211], v[44:51], v19
    v_exp_f32 v22, v22
    v_exp_f32 v23, v23
    v_exp_f32 v24, v24
    v_mfma_f32_32x32x16_bf16 v[36:51], v[120:123], v[220:223], 0
    v_exp_f32 v25, v25
    v_exp_f32 v26, v26
    v_exp_f32 v27, v27
    v_exp_f32 v28, v28
    v_exp_f32 v29, v29
    v_exp_f32 v30, v30
    v_smfmac_f32_32x32x32_bf16 v[72:87], v[148:151], v[20:27], v19
    v_exp_f32 v31, v31
    v_exp_f32 v32, v32
    v_exp_f32 v33, v33
    v_exp_f32 v34, v34
    v_exp_f32 v35, v35
    v_exp_f32 v36, v36
    v_exp_f32 v37, v37
    v_smfmac_f32_32x32x32_bf16 v[72:87], v[152:155], v[28:35], v19
    v_exp_f32 v38, v38
    v_exp_f32 v39, v39
    v_exp_f32 v40, v40
    v_mfma_f32_32x32x16_bf16 v[20:35], v[124:127], v[220:223], 0
    v_exp_f32 v41, v41
    v_exp_f32 v42, v42
    v_exp_f32 v43, v43
    v_exp_f32 v44, v44
    v_exp_f32 v45, v45
    v_exp_f32 v46, v46
    v_smfmac_f32_32x32x32_bf16 v[72:87], v[156:159], v[36:43], v19
    ds_write_b128 v4, v[62:65] offset:9216
    v_exp_f32 v47, v47
    v_exp_f32 v48, v48
    v_exp_f32 v49, v49
    v_exp_f32 v50, v50
    v_exp_f32 v51, v51
    v_exp_f32 v20, v20
    v_exp_f32 v21, v21
    v_smfmac_f32_32x32x32_bf16 v[72:87], v[160:163], v[44:51], v19
    v_exp_f32 v22, v22
    v_exp_f32 v23, v23
    v_exp_f32 v24, v24
    v_mfma_f32_32x32x16_bf16 v[36:51], v[128:131], v[220:223], 0
    v_exp_f32 v25, v25
    v_exp_f32 v26, v26
    v_exp_f32 v27, v27
    v_exp_f32 v28, v28
    v_exp_f32 v29, v29
    v_exp_f32 v30, v30
    v_smfmac_f32_32x32x32_bf16 v[72:87], v[164:167], v[20:27], v19
    ds_write_b128 v5, v[66:69] offset:9216
    v_exp_f32 v31, v31
    v_exp_f32 v32, v32
    v_exp_f32 v33, v33
    v_exp_f32 v34, v34
    v_exp_f32 v35, v35
    v_exp_f32 v36, v36
    v_exp_f32 v37, v37
    v_smfmac_f32_32x32x32_bf16 v[72:87], v[168:171], v[28:35], v19
    v_exp_f32 v38, v38
    v_exp_f32 v39, v39
    v_exp_f32 v40, v40
    v_mfma_f32_32x32x16_bf16 v[20:35], v[132:135], v[220:223], 0
    v_exp_f32 v41, v41
    v_exp_f32 v42, v42
    v_exp_f32 v43, v43
    v_exp_f32 v44, v44
    v_exp_f32 v45, v45
    v_exp_f32 v46, v46
    v_smfmac_f32_32x32x32_bf16 v[72:87], v[172:175], v[36:43], v19
    ds_write_b32 v6, v70 offset:9216
    v_exp_f32 v47, v47
    v_exp_f32 v48, v48
    v_exp_f32 v49, v49
    v_exp_f32 v50, v50
    v_exp_f32 v51, v51
    v_exp_f32 v20, v20
    v_exp_f32 v21, v21
    v_smfmac_f32_32x32x32_bf16 v[72:87], v[176:179], v[44:51], v19
    v_exp_f32 v22, v22
    v_exp_f32 v23, v23
    v_exp_f32 v24, v24
    v_mfma_f32_32x32x16_bf16 v[36:51], v[136:139], v[220:223], 0
    v_exp_f32 v25, v25
    v_exp_f32 v26, v26
    v_exp_f32 v27, v27
    v_exp_f32 v28, v28
    v_exp_f32 v29, v29
    v_exp_f32 v30, v30
    v_smfmac_f32_32x32x32_bf16 v[72:87], v[180:183], v[20:27], v19
    v_exp_f32 v31, v31
    v_exp_f32 v32, v32
    v_exp_f32 v33, v33
    v_exp_f32 v34, v34
    v_exp_f32 v35, v35
    v_exp_f32 v36, v36
    v_exp_f32 v37, v37
    v_smfmac_f32_32x32x32_bf16 v[72:87], v[184:187], v[28:35], v19
    v_exp_f32 v38, v38
    v_exp_f32 v39, v39
    v_exp_f32 v40, v40
    v_mfma_f32_32x32x16_bf16 v[20:35], v[140:143], v[220:223], 0
    v_exp_f32 v41, v41
    v_exp_f32 v42, v42
    v_exp_f32 v43, v43
    v_exp_f32 v44, v44
    v_exp_f32 v45, v45
    v_exp_f32 v46, v46
    v_smfmac_f32_32x32x32_bf16 v[72:87], v[188:191], v[36:43], v19
    v_exp_f32 v47, v47
    v_exp_f32 v48, v48
    v_exp_f32 v49, v49
    v_exp_f32 v50, v50
    v_exp_f32 v51, v51
    v_exp_f32 v20, v20
    v_exp_f32 v21, v21
    v_smfmac_f32_32x32x32_bf16 v[72:87], v[192:195], v[44:51], v19
    v_exp_f32 v22, v22
    v_exp_f32 v23, v23
    v_exp_f32 v24, v24
    v_mfma_f32_32x32x16_bf16 v[36:51], v[144:147], v[220:223], 0
    v_exp_f32 v25, v25
    v_exp_f32 v26, v26
    v_exp_f32 v27, v27
    v_exp_f32 v28, v28
    v_exp_f32 v29, v29
    v_exp_f32 v30, v30
    v_smfmac_f32_32x32x32_bf16 v[72:87], v[196:199], v[20:27], v19
    v_exp_f32 v31, v31
    v_exp_f32 v32, v32
    v_exp_f32 v33, v33
    v_exp_f32 v34, v34
    v_exp_f32 v35, v35
    v_exp_f32 v36, v36
    v_exp_f32 v37, v37
    v_smfmac_f32_32x32x32_bf16 v[72:87], v[200:203], v[28:35], v19
    v_exp_f32 v38, v38
    v_exp_f32 v39, v39
    v_exp_f32 v40, v40
    v_mfma_f32_32x32x16_bf16 v[20:35], v[116:119], v[224:227], 0
    v_exp_f32 v41, v41
    v_exp_f32 v42, v42
    v_exp_f32 v43, v43
    v_exp_f32 v44, v44
    v_exp_f32 v45, v45
    v_exp_f32 v46, v46
    v_smfmac_f32_32x32x32_bf16 v[72:87], v[204:207], v[36:43], v19
    v_exp_f32 v47, v47
    v_exp_f32 v48, v48
    v_exp_f32 v49, v49
    v_exp_f32 v50, v50
    v_exp_f32 v51, v51
    v_exp_f32 v20, v20
    v_exp_f32 v21, v21
    v_smfmac_f32_32x32x32_bf16 v[72:87], v[208:211], v[44:51], v19
    v_exp_f32 v22, v22
    v_exp_f32 v23, v23
    v_exp_f32 v24, v24
    v_mfma_f32_32x32x16_bf16 v[36:51], v[120:123], v[224:227], 0
    v_exp_f32 v25, v25
    v_exp_f32 v26, v26
    v_exp_f32 v27, v27
    v_exp_f32 v28, v28
    v_exp_f32 v29, v29
    v_exp_f32 v30, v30
    v_smfmac_f32_32x32x32_bf16 v[82:97], v[148:151], v[20:27], v19
    v_exp_f32 v31, v31
    v_exp_f32 v32, v32
    v_exp_f32 v33, v33
    v_exp_f32 v34, v34
    v_exp_f32 v35, v35
    v_exp_f32 v36, v36
    v_exp_f32 v37, v37
    v_smfmac_f32_32x32x32_bf16 v[82:97], v[152:155], v[28:35], v19
    v_exp_f32 v38, v38
    v_exp_f32 v39, v39
    v_exp_f32 v40, v40
    v_mfma_f32_32x32x16_bf16 v[20:35], v[124:127], v[224:227], 0
    v_exp_f32 v41, v41
    v_exp_f32 v42, v42
    v_exp_f32 v43, v43
    v_exp_f32 v44, v44
    v_exp_f32 v45, v45
    v_exp_f32 v46, v46
    v_smfmac_f32_32x32x32_bf16 v[82:97], v[156:159], v[36:43], v19
    ds_write_b128 v4, v[72:75] offset:18432
    v_exp_f32 v47, v47
    v_exp_f32 v48, v48
    v_exp_f32 v49, v49
    v_exp_f32 v50, v50
    v_exp_f32 v51, v51
    v_exp_f32 v20, v20
    v_exp_f32 v21, v21
    v_smfmac_f32_32x32x32_bf16 v[82:97], v[160:163], v[44:51], v19
    v_exp_f32 v22, v22
    v_exp_f32 v23, v23
    v_exp_f32 v24, v24
    v_mfma_f32_32x32x16_bf16 v[36:51], v[128:131], v[224:227], 0
    v_exp_f32 v25, v25
    v_exp_f32 v26, v26
    v_exp_f32 v27, v27
    v_exp_f32 v28, v28
    v_exp_f32 v29, v29
    v_exp_f32 v30, v30
    v_smfmac_f32_32x32x32_bf16 v[82:97], v[164:167], v[20:27], v19
    ds_write_b128 v5, v[76:79] offset:18432
    v_exp_f32 v31, v31
    v_exp_f32 v32, v32
    v_exp_f32 v33, v33
    v_exp_f32 v34, v34
    v_exp_f32 v35, v35
    v_exp_f32 v36, v36
    v_exp_f32 v37, v37
    v_smfmac_f32_32x32x32_bf16 v[82:97], v[168:171], v[28:35], v19
    v_exp_f32 v38, v38
    v_exp_f32 v39, v39
    v_exp_f32 v40, v40
    v_mfma_f32_32x32x16_bf16 v[20:35], v[132:135], v[224:227], 0
    v_exp_f32 v41, v41
    v_exp_f32 v42, v42
    v_exp_f32 v43, v43
    v_exp_f32 v44, v44
    v_exp_f32 v45, v45
    v_exp_f32 v46, v46
    v_smfmac_f32_32x32x32_bf16 v[82:97], v[172:175], v[36:43], v19
    ds_write_b32 v6, v80 offset:18432
    v_exp_f32 v47, v47
    v_exp_f32 v48, v48
    v_exp_f32 v49, v49
    v_exp_f32 v50, v50
    v_exp_f32 v51, v51
    v_exp_f32 v20, v20
    v_exp_f32 v21, v21
    v_smfmac_f32_32x32x32_bf16 v[82:97], v[176:179], v[44:51], v19
    v_exp_f32 v22, v22
    v_exp_f32 v23, v23
    v_exp_f32 v24, v24
    v_mfma_f32_32x32x16_bf16 v[36:51], v[136:139], v[224:227], 0
    v_exp_f32 v25, v25
    v_exp_f32 v26, v26
    v_exp_f32 v27, v27
    v_exp_f32 v28, v28
    v_exp_f32 v29, v29
    v_exp_f32 v30, v30
    v_smfmac_f32_32x32x32_bf16 v[82:97], v[180:183], v[20:27], v19
    v_exp_f32 v31, v31
    v_exp_f32 v32, v32
    v_exp_f32 v33, v33
    v_exp_f32 v34, v34
    v_exp_f32 v35, v35
    v_exp_f32 v36, v36
    v_exp_f32 v37, v37
    v_smfmac_f32_32x32x32_bf16 v[82:97], v[184:187], v[28:35], v19
    v_exp_f32 v38, v38
    v_exp_f32 v39, v39
    v_exp_f32 v40, v40
    v_mfma_f32_32x32x16_bf16 v[20:35], v[140:143], v[224:227], 0
    v_exp_f32 v41, v41
    v_exp_f32 v42, v42
    v_exp_f32 v43, v43
    v_exp_f32 v44, v44
    v_exp_f32 v45, v45
    v_exp_f32 v46, v46
    v_smfmac_f32_32x32x32_bf16 v[82:97], v[188:191], v[36:43], v19
    v_exp_f32 v47, v47
    v_exp_f32 v48, v48
    v_exp_f32 v49, v49
    v_exp_f32 v50, v50
    v_exp_f32 v51, v51
    v_exp_f32 v20, v20
    v_exp_f32 v21, v21
    v_smfmac_f32_32x32x32_bf16 v[82:97], v[192:195], v[44:51], v19
    v_exp_f32 v22, v22
    v_exp_f32 v23, v23
    v_exp_f32 v24, v24
    v_mfma_f32_32x32x16_bf16 v[36:51], v[144:147], v[224:227], 0
    v_exp_f32 v25, v25
    v_exp_f32 v26, v26
    v_exp_f32 v27, v27
    v_exp_f32 v28, v28
    v_exp_f32 v29, v29
    v_exp_f32 v30, v30
    v_smfmac_f32_32x32x32_bf16 v[82:97], v[196:199], v[20:27], v19
    v_exp_f32 v31, v31
    v_exp_f32 v32, v32
    v_exp_f32 v33, v33
    v_exp_f32 v34, v34
    v_exp_f32 v35, v35
    v_exp_f32 v36, v36
    v_exp_f32 v37, v37
    v_smfmac_f32_32x32x32_bf16 v[82:97], v[200:203], v[28:35], v19
    v_exp_f32 v38, v38
    v_exp_f32 v39, v39
    v_exp_f32 v40, v40
    v_mfma_f32_32x32x16_bf16 v[20:35], v[116:119], v[228:231], 0
    v_exp_f32 v41, v41
    v_exp_f32 v42, v42
    v_exp_f32 v43, v43
    v_exp_f32 v44, v44
    v_exp_f32 v45, v45
    v_exp_f32 v46, v46
    v_smfmac_f32_32x32x32_bf16 v[82:97], v[204:207], v[36:43], v19
    v_exp_f32 v47, v47
    v_exp_f32 v48, v48
    v_exp_f32 v49, v49
    v_exp_f32 v50, v50
    v_exp_f32 v51, v51
    v_exp_f32 v20, v20
    v_exp_f32 v21, v21
    v_smfmac_f32_32x32x32_bf16 v[82:97], v[208:211], v[44:51], v19
    v_exp_f32 v22, v22
    v_exp_f32 v23, v23
    v_exp_f32 v24, v24
    v_mfma_f32_32x32x16_bf16 v[36:51], v[120:123], v[228:231], 0
    v_exp_f32 v25, v25
    v_exp_f32 v26, v26
    v_exp_f32 v27, v27
    v_exp_f32 v28, v28
    v_exp_f32 v29, v29
    v_exp_f32 v30, v30
    v_smfmac_f32_32x32x32_bf16 v[92:107], v[148:151], v[20:27], v19
    v_exp_f32 v31, v31
    v_exp_f32 v32, v32
    v_exp_f32 v33, v33
    v_exp_f32 v34, v34
    v_exp_f32 v35, v35
    v_exp_f32 v36, v36
    v_exp_f32 v37, v37
    v_smfmac_f32_32x32x32_bf16 v[92:107], v[152:155], v[28:35], v19
    v_exp_f32 v38, v38
    v_exp_f32 v39, v39
    v_exp_f32 v40, v40
    v_mfma_f32_32x32x16_bf16 v[20:35], v[124:127], v[228:231], 0
    v_exp_f32 v41, v41
    v_exp_f32 v42, v42
    v_exp_f32 v43, v43
    v_exp_f32 v44, v44
    v_exp_f32 v45, v45
    v_exp_f32 v46, v46
    v_smfmac_f32_32x32x32_bf16 v[92:107], v[156:159], v[36:43], v19
    ds_write_b128 v4, v[82:85] offset:27648
    v_exp_f32 v47, v47
    v_exp_f32 v48, v48
    v_exp_f32 v49, v49
    v_exp_f32 v50, v50
    v_exp_f32 v51, v51
    v_exp_f32 v20, v20
    v_exp_f32 v21, v21
    v_smfmac_f32_32x32x32_bf16 v[92:107], v[160:163], v[44:51], v19
    v_exp_f32 v22, v22
    v_exp_f32 v23, v23
    v_exp_f32 v24, v24
    v_mfma_f32_32x32x16_bf16 v[36:51], v[128:131], v[228:231], 0
    v_exp_f32 v25, v25
    v_exp_f32 v26, v26
    v_exp_f32 v27, v27
    v_exp_f32 v28, v28
    v_exp_f32 v29, v29
    v_exp_f32 v30, v30
    v_smfmac_f32_32x32x32_bf16 v[92:107], v[164:167], v[20:27], v19
    ds_write_b128 v5, v[86:89] offset:27648
    v_exp_f32 v31, v31
    v_exp_f32 v32, v32
    v_exp_f32 v33, v33
    v_exp_f32 v34, v34
    v_exp_f32 v35, v35
    v_exp_f32 v36, v36
    v_exp_f32 v37, v37
    v_smfmac_f32_32x32x32_bf16 v[92:107], v[168:171], v[28:35], v19
    v_exp_f32 v38, v38
    v_exp_f32 v39, v39
    v_exp_f32 v40, v40
    v_mfma_f32_32x32x16_bf16 v[20:35], v[132:135], v[228:231], 0
    v_exp_f32 v41, v41
    v_exp_f32 v42, v42
    v_exp_f32 v43, v43
    v_exp_f32 v44, v44
    v_exp_f32 v45, v45
    v_exp_f32 v46, v46
    v_smfmac_f32_32x32x32_bf16 v[92:107], v[172:175], v[36:43], v19
    ds_write_b32 v6, v90 offset:27648
    v_exp_f32 v47, v47
    v_exp_f32 v48, v48
    v_exp_f32 v49, v49
    v_exp_f32 v50, v50
    v_exp_f32 v51, v51
    v_exp_f32 v20, v20
    v_exp_f32 v21, v21
    v_smfmac_f32_32x32x32_bf16 v[92:107], v[176:179], v[44:51], v19
    s_waitcnt vmcnt(0) lgkmcnt(0)
    s_barrier
    v_exp_f32 v22, v22
    v_exp_f32 v23, v23
    v_exp_f32 v24, v24
    v_mfma_f32_32x32x16_bf16 v[36:51], v[136:139], v[228:231], 0
    v_exp_f32 v25, v25
    v_exp_f32 v26, v26
    v_exp_f32 v27, v27
    v_exp_f32 v28, v28
    v_exp_f32 v29, v29
    v_exp_f32 v30, v30
    v_smfmac_f32_32x32x32_bf16 v[92:107], v[180:183], v[20:27], v19
    ds_read_b128 v[62:65], v4 offset:55296
    v_exp_f32 v31, v31
    v_exp_f32 v32, v32
    v_exp_f32 v33, v33
    v_exp_f32 v34, v34
    v_exp_f32 v35, v35
    v_exp_f32 v36, v36
    v_exp_f32 v37, v37
    v_smfmac_f32_32x32x32_bf16 v[92:107], v[184:187], v[28:35], v19
    ds_read_b128 v[52:55], v4 offset:46080
    ds_read_b128 v[72:75], v4 offset:64512
    v_exp_f32 v38, v38
    v_exp_f32 v39, v39
    v_exp_f32 v40, v40
    v_mfma_f32_32x32x16_bf16 v[20:35], v[140:143], v[228:231], 0
    v_exp_f32 v41, v41
    v_exp_f32 v42, v42
    v_exp_f32 v43, v43
    v_exp_f32 v44, v44
    v_exp_f32 v45, v45
    v_exp_f32 v46, v46
    v_smfmac_f32_32x32x32_bf16 v[92:107], v[188:191], v[36:43], v19
    ds_read_b128 v[66:69], v5 offset:55296
    v_exp_f32 v47, v47
    v_exp_f32 v48, v48
    v_exp_f32 v49, v49
    v_exp_f32 v50, v50
    v_exp_f32 v51, v51
    v_exp_f32 v20, v20
    v_exp_f32 v21, v21
    v_smfmac_f32_32x32x32_bf16 v[92:107], v[192:195], v[44:51], v19
    ds_read_b128 v[56:59], v5 offset:46080
    ds_read_b128 v[76:79], v5 offset:64512
    v_exp_f32 v22, v22
    v_exp_f32 v23, v23
    v_exp_f32 v24, v24
    v_mfma_f32_32x32x16_bf16 v[36:51], v[144:147], v[228:231], 0
    v_exp_f32 v25, v25
    v_exp_f32 v26, v26
    v_exp_f32 v27, v27
    v_exp_f32 v28, v28
    v_exp_f32 v29, v29
    v_exp_f32 v30, v30
    v_smfmac_f32_32x32x32_bf16 v[92:107], v[196:199], v[20:27], v19
    ds_read_b32 v70, v6 offset:55296
    v_exp_f32 v31, v31
    v_exp_f32 v32, v32
    v_exp_f32 v33, v33
    v_exp_f32 v34, v34
    v_exp_f32 v35, v35
    v_exp_f32 v36, v36
    v_exp_f32 v37, v37
    v_smfmac_f32_32x32x32_bf16 v[92:107], v[200:203], v[28:35], v19
    ds_read_b32 v60, v6 offset:46080
    ds_read_b32 v80, v6 offset:64512
    v_exp_f32 v38, v38
    v_exp_f32 v39, v39
    v_exp_f32 v40, v40
    v_mfma_f32_32x32x16_bf16 v[20:35], v[116:119], v[232:235], 0
    v_exp_f32 v41, v41
    v_exp_f32 v42, v42
    v_exp_f32 v43, v43
    v_exp_f32 v44, v44
    v_exp_f32 v45, v45
    v_exp_f32 v46, v46
    v_smfmac_f32_32x32x32_bf16 v[92:107], v[204:207], v[36:43], v19
    v_exp_f32 v47, v47
    v_exp_f32 v48, v48
    v_exp_f32 v49, v49
    v_exp_f32 v50, v50
    v_exp_f32 v51, v51
    v_exp_f32 v20, v20
    v_exp_f32 v21, v21
    v_smfmac_f32_32x32x32_bf16 v[92:107], v[208:211], v[44:51], v19
    v_exp_f32 v22, v22
    v_exp_f32 v23, v23
    v_exp_f32 v24, v24
    v_mfma_f32_32x32x16_bf16 v[36:51], v[120:123], v[232:235], 0
    s_waitcnt lgkmcnt(0)
    v_exp_f32 v25, v25
    v_exp_f32 v26, v26
    v_exp_f32 v27, v27
    v_exp_f32 v28, v28
    v_exp_f32 v29, v29
    v_exp_f32 v30, v30
    v_smfmac_f32_32x32x32_bf16 v[52:67], v[148:151], v[20:27], v19
    v_exp_f32 v31, v31
    v_exp_f32 v32, v32
    v_exp_f32 v33, v33
    v_exp_f32 v34, v34
    v_exp_f32 v35, v35
    v_exp_f32 v36, v36
    v_exp_f32 v37, v37
    v_smfmac_f32_32x32x32_bf16 v[52:67], v[152:155], v[28:35], v19
    v_exp_f32 v38, v38
    v_exp_f32 v39, v39
    v_exp_f32 v40, v40
    v_mfma_f32_32x32x16_bf16 v[20:35], v[124:127], v[232:235], 0
    v_exp_f32 v41, v41
    v_exp_f32 v42, v42
    v_exp_f32 v43, v43
    v_exp_f32 v44, v44
    v_exp_f32 v45, v45
    v_exp_f32 v46, v46
    v_smfmac_f32_32x32x32_bf16 v[52:67], v[156:159], v[36:43], v19
    ds_write_b128 v4, v[92:95] offset:36864
    v_exp_f32 v47, v47
    v_exp_f32 v48, v48
    v_exp_f32 v49, v49
    v_exp_f32 v50, v50
    v_exp_f32 v51, v51
    v_exp_f32 v20, v20
    v_exp_f32 v21, v21
    v_smfmac_f32_32x32x32_bf16 v[52:67], v[160:163], v[44:51], v19
    v_exp_f32 v22, v22
    v_exp_f32 v23, v23
    v_exp_f32 v24, v24
    v_mfma_f32_32x32x16_bf16 v[36:51], v[128:131], v[232:235], 0
    v_exp_f32 v25, v25
    v_exp_f32 v26, v26
    v_exp_f32 v27, v27
    v_exp_f32 v28, v28
    v_exp_f32 v29, v29
    v_exp_f32 v30, v30
    v_smfmac_f32_32x32x32_bf16 v[52:67], v[164:167], v[20:27], v19
    ds_write_b128 v5, v[96:99] offset:36864
    v_exp_f32 v31, v31
    v_exp_f32 v32, v32
    v_exp_f32 v33, v33
    v_exp_f32 v34, v34
    v_exp_f32 v35, v35
    v_exp_f32 v36, v36
    v_exp_f32 v37, v37
    v_smfmac_f32_32x32x32_bf16 v[52:67], v[168:171], v[28:35], v19
    v_exp_f32 v38, v38
    v_exp_f32 v39, v39
    v_exp_f32 v40, v40
    v_mfma_f32_32x32x16_bf16 v[20:35], v[132:135], v[232:235], 0
    v_exp_f32 v41, v41
    v_exp_f32 v42, v42
    v_exp_f32 v43, v43
    v_exp_f32 v44, v44
    v_exp_f32 v45, v45
    v_exp_f32 v46, v46
    v_smfmac_f32_32x32x32_bf16 v[52:67], v[172:175], v[36:43], v19
    ds_write_b32 v6, v100 offset:36864
    v_exp_f32 v47, v47
    v_exp_f32 v48, v48
    v_exp_f32 v49, v49
    v_exp_f32 v50, v50
    v_exp_f32 v51, v51
    v_exp_f32 v20, v20
    v_exp_f32 v21, v21
    v_smfmac_f32_32x32x32_bf16 v[52:67], v[176:179], v[44:51], v19
    v_exp_f32 v22, v22
    v_exp_f32 v23, v23
    v_exp_f32 v24, v24
    v_mfma_f32_32x32x16_bf16 v[36:51], v[136:139], v[232:235], 0
    v_exp_f32 v25, v25
    v_exp_f32 v26, v26
    v_exp_f32 v27, v27
    v_exp_f32 v28, v28
    v_exp_f32 v29, v29
    v_exp_f32 v30, v30
    v_smfmac_f32_32x32x32_bf16 v[52:67], v[180:183], v[20:27], v19
    v_exp_f32 v31, v31
    v_exp_f32 v32, v32
    v_exp_f32 v33, v33
    v_exp_f32 v34, v34
    v_exp_f32 v35, v35
    v_exp_f32 v36, v36
    v_exp_f32 v37, v37
    v_smfmac_f32_32x32x32_bf16 v[52:67], v[184:187], v[28:35], v19
    v_exp_f32 v38, v38
    v_exp_f32 v39, v39
    v_exp_f32 v40, v40
    v_mfma_f32_32x32x16_bf16 v[20:35], v[140:143], v[232:235], 0
    v_exp_f32 v41, v41
    v_exp_f32 v42, v42
    v_exp_f32 v43, v43
    v_exp_f32 v44, v44
    v_exp_f32 v45, v45
    v_exp_f32 v46, v46
    v_smfmac_f32_32x32x32_bf16 v[52:67], v[188:191], v[36:43], v19
    v_exp_f32 v47, v47
    v_exp_f32 v48, v48
    v_exp_f32 v49, v49
    v_exp_f32 v50, v50
    v_exp_f32 v51, v51
    v_exp_f32 v20, v20
    v_exp_f32 v21, v21
    v_smfmac_f32_32x32x32_bf16 v[52:67], v[192:195], v[44:51], v19
    v_exp_f32 v22, v22
    v_exp_f32 v23, v23
    v_exp_f32 v24, v24
    v_mfma_f32_32x32x16_bf16 v[36:51], v[144:147], v[232:235], 0
    v_exp_f32 v25, v25
    v_exp_f32 v26, v26
    v_exp_f32 v27, v27
    v_exp_f32 v28, v28
    v_exp_f32 v29, v29
    v_exp_f32 v30, v30
    v_smfmac_f32_32x32x32_bf16 v[52:67], v[196:199], v[20:27], v19
    v_exp_f32 v31, v31
    v_exp_f32 v32, v32
    v_exp_f32 v33, v33
    v_exp_f32 v34, v34
    v_exp_f32 v35, v35
    v_exp_f32 v36, v36
    v_exp_f32 v37, v37
    v_smfmac_f32_32x32x32_bf16 v[52:67], v[200:203], v[28:35], v19
    v_exp_f32 v38, v38
    v_exp_f32 v39, v39
    v_exp_f32 v40, v40
    v_mfma_f32_32x32x16_bf16 v[20:35], v[116:119], v[236:239], 0
    v_exp_f32 v41, v41
    v_exp_f32 v42, v42
    v_exp_f32 v43, v43
    v_exp_f32 v44, v44
    v_exp_f32 v45, v45
    v_exp_f32 v46, v46
    v_smfmac_f32_32x32x32_bf16 v[52:67], v[204:207], v[36:43], v19
    v_exp_f32 v47, v47
    v_exp_f32 v48, v48
    v_exp_f32 v49, v49
    v_exp_f32 v50, v50
    v_exp_f32 v51, v51
    v_exp_f32 v20, v20
    v_exp_f32 v21, v21
    v_smfmac_f32_32x32x32_bf16 v[52:67], v[208:211], v[44:51], v19
    v_exp_f32 v22, v22
    v_exp_f32 v23, v23
    v_exp_f32 v24, v24
    v_mfma_f32_32x32x16_bf16 v[36:51], v[120:123], v[236:239], 0
    v_exp_f32 v25, v25
    v_exp_f32 v26, v26
    v_exp_f32 v27, v27
    v_exp_f32 v28, v28
    v_exp_f32 v29, v29
    v_exp_f32 v30, v30
    v_smfmac_f32_32x32x32_bf16 v[62:77], v[148:151], v[20:27], v19
    v_exp_f32 v31, v31
    v_exp_f32 v32, v32
    v_exp_f32 v33, v33
    v_exp_f32 v34, v34
    v_exp_f32 v35, v35
    v_exp_f32 v36, v36
    v_exp_f32 v37, v37
    v_smfmac_f32_32x32x32_bf16 v[62:77], v[152:155], v[28:35], v19
    v_exp_f32 v38, v38
    v_exp_f32 v39, v39
    v_exp_f32 v40, v40
    v_mfma_f32_32x32x16_bf16 v[20:35], v[124:127], v[236:239], 0
    v_exp_f32 v41, v41
    v_exp_f32 v42, v42
    v_exp_f32 v43, v43
    v_exp_f32 v44, v44
    v_exp_f32 v45, v45
    v_exp_f32 v46, v46
    v_smfmac_f32_32x32x32_bf16 v[62:77], v[156:159], v[36:43], v19
    ds_write_b128 v4, v[52:55] offset:46080
    v_exp_f32 v47, v47
    v_exp_f32 v48, v48
    v_exp_f32 v49, v49
    v_exp_f32 v50, v50
    v_exp_f32 v51, v51
    v_exp_f32 v20, v20
    v_exp_f32 v21, v21
    v_smfmac_f32_32x32x32_bf16 v[62:77], v[160:163], v[44:51], v19
    v_exp_f32 v22, v22
    v_exp_f32 v23, v23
    v_exp_f32 v24, v24
    v_mfma_f32_32x32x16_bf16 v[36:51], v[128:131], v[236:239], 0
    v_exp_f32 v25, v25
    v_exp_f32 v26, v26
    v_exp_f32 v27, v27
    v_exp_f32 v28, v28
    v_exp_f32 v29, v29
    v_exp_f32 v30, v30
    v_smfmac_f32_32x32x32_bf16 v[62:77], v[164:167], v[20:27], v19
    ds_write_b128 v5, v[56:59] offset:46080
    v_exp_f32 v31, v31
    v_exp_f32 v32, v32
    v_exp_f32 v33, v33
    v_exp_f32 v34, v34
    v_exp_f32 v35, v35
    v_exp_f32 v36, v36
    v_exp_f32 v37, v37
    v_smfmac_f32_32x32x32_bf16 v[62:77], v[168:171], v[28:35], v19
    v_exp_f32 v38, v38
    v_exp_f32 v39, v39
    v_exp_f32 v40, v40
    v_mfma_f32_32x32x16_bf16 v[20:35], v[132:135], v[236:239], 0
    v_exp_f32 v41, v41
    v_exp_f32 v42, v42
    v_exp_f32 v43, v43
    v_exp_f32 v44, v44
    v_exp_f32 v45, v45
    v_exp_f32 v46, v46
    v_smfmac_f32_32x32x32_bf16 v[62:77], v[172:175], v[36:43], v19
    ds_write_b32 v6, v60 offset:46080
    v_exp_f32 v47, v47
    v_exp_f32 v48, v48
    v_exp_f32 v49, v49
    v_exp_f32 v50, v50
    v_exp_f32 v51, v51
    v_exp_f32 v20, v20
    v_exp_f32 v21, v21
    v_smfmac_f32_32x32x32_bf16 v[62:77], v[176:179], v[44:51], v19
    v_exp_f32 v22, v22
    v_exp_f32 v23, v23
    v_exp_f32 v24, v24
    v_mfma_f32_32x32x16_bf16 v[36:51], v[136:139], v[236:239], 0
    v_exp_f32 v25, v25
    v_exp_f32 v26, v26
    v_exp_f32 v27, v27
    v_exp_f32 v28, v28
    v_exp_f32 v29, v29
    v_exp_f32 v30, v30
    v_smfmac_f32_32x32x32_bf16 v[62:77], v[180:183], v[20:27], v19
    v_exp_f32 v31, v31
    v_exp_f32 v32, v32
    v_exp_f32 v33, v33
    v_exp_f32 v34, v34
    v_exp_f32 v35, v35
    v_exp_f32 v36, v36
    v_exp_f32 v37, v37
    v_smfmac_f32_32x32x32_bf16 v[62:77], v[184:187], v[28:35], v19
    v_exp_f32 v38, v38
    v_exp_f32 v39, v39
    v_exp_f32 v40, v40
    v_mfma_f32_32x32x16_bf16 v[20:35], v[140:143], v[236:239], 0
    v_exp_f32 v41, v41
    v_exp_f32 v42, v42
    v_exp_f32 v43, v43
    v_exp_f32 v44, v44
    v_exp_f32 v45, v45
    v_exp_f32 v46, v46
    v_smfmac_f32_32x32x32_bf16 v[62:77], v[188:191], v[36:43], v19
    v_exp_f32 v47, v47
    v_exp_f32 v48, v48
    v_exp_f32 v49, v49
    v_exp_f32 v50, v50
    v_exp_f32 v51, v51
    v_exp_f32 v20, v20
    v_exp_f32 v21, v21
    v_smfmac_f32_32x32x32_bf16 v[62:77], v[192:195], v[44:51], v19
    v_exp_f32 v22, v22
    v_exp_f32 v23, v23
    v_exp_f32 v24, v24
    v_mfma_f32_32x32x16_bf16 v[36:51], v[144:147], v[236:239], 0
    v_exp_f32 v25, v25
    v_exp_f32 v26, v26
    v_exp_f32 v27, v27
    v_exp_f32 v28, v28
    v_exp_f32 v29, v29
    v_exp_f32 v30, v30
    v_smfmac_f32_32x32x32_bf16 v[62:77], v[196:199], v[20:27], v19
    v_exp_f32 v31, v31
    v_exp_f32 v32, v32
    v_exp_f32 v33, v33
    v_exp_f32 v34, v34
    v_exp_f32 v35, v35
    v_exp_f32 v36, v36
    v_exp_f32 v37, v37
    v_smfmac_f32_32x32x32_bf16 v[62:77], v[200:203], v[28:35], v19
    v_exp_f32 v38, v38
    v_exp_f32 v39, v39
    v_exp_f32 v40, v40
    v_mfma_f32_32x32x16_bf16 v[20:35], v[116:119], v[240:243], 0
    v_exp_f32 v41, v41
    v_exp_f32 v42, v42
    v_exp_f32 v43, v43
    v_exp_f32 v44, v44
    v_exp_f32 v45, v45
    v_exp_f32 v46, v46
    v_smfmac_f32_32x32x32_bf16 v[62:77], v[204:207], v[36:43], v19
    v_exp_f32 v47, v47
    v_exp_f32 v48, v48
    v_exp_f32 v49, v49
    v_exp_f32 v50, v50
    v_exp_f32 v51, v51
    v_exp_f32 v20, v20
    v_exp_f32 v21, v21
    v_smfmac_f32_32x32x32_bf16 v[62:77], v[208:211], v[44:51], v19
    v_exp_f32 v22, v22
    v_exp_f32 v23, v23
    v_exp_f32 v24, v24
    v_mfma_f32_32x32x16_bf16 v[36:51], v[120:123], v[240:243], 0
    v_exp_f32 v25, v25
    v_exp_f32 v26, v26
    v_exp_f32 v27, v27
    v_exp_f32 v28, v28
    v_exp_f32 v29, v29
    v_exp_f32 v30, v30
    v_smfmac_f32_32x32x32_bf16 v[72:87], v[148:151], v[20:27], v19
    v_exp_f32 v31, v31
    v_exp_f32 v32, v32
    v_exp_f32 v33, v33
    v_exp_f32 v34, v34
    v_exp_f32 v35, v35
    v_exp_f32 v36, v36
    v_exp_f32 v37, v37
    v_smfmac_f32_32x32x32_bf16 v[72:87], v[152:155], v[28:35], v19
    v_exp_f32 v38, v38
    v_exp_f32 v39, v39
    v_exp_f32 v40, v40
    v_mfma_f32_32x32x16_bf16 v[20:35], v[124:127], v[240:243], 0
    v_exp_f32 v41, v41
    v_exp_f32 v42, v42
    v_exp_f32 v43, v43
    v_exp_f32 v44, v44
    v_exp_f32 v45, v45
    v_exp_f32 v46, v46
    v_smfmac_f32_32x32x32_bf16 v[72:87], v[156:159], v[36:43], v19
    ds_write_b128 v4, v[62:65] offset:55296
    v_exp_f32 v47, v47
    v_exp_f32 v48, v48
    v_exp_f32 v49, v49
    v_exp_f32 v50, v50
    v_exp_f32 v51, v51
    v_exp_f32 v20, v20
    v_exp_f32 v21, v21
    v_smfmac_f32_32x32x32_bf16 v[72:87], v[160:163], v[44:51], v19
    v_exp_f32 v22, v22
    v_exp_f32 v23, v23
    v_exp_f32 v24, v24
    v_mfma_f32_32x32x16_bf16 v[36:51], v[128:131], v[240:243], 0
    v_exp_f32 v25, v25
    v_exp_f32 v26, v26
    v_exp_f32 v27, v27
    v_exp_f32 v28, v28
    v_exp_f32 v29, v29
    v_exp_f32 v30, v30
    v_smfmac_f32_32x32x32_bf16 v[72:87], v[164:167], v[20:27], v19
    ds_write_b128 v5, v[66:69] offset:55296
    v_exp_f32 v31, v31
    v_exp_f32 v32, v32
    v_exp_f32 v33, v33
    v_exp_f32 v34, v34
    v_exp_f32 v35, v35
    v_exp_f32 v36, v36
    v_exp_f32 v37, v37
    v_smfmac_f32_32x32x32_bf16 v[72:87], v[168:171], v[28:35], v19
    v_exp_f32 v38, v38
    v_exp_f32 v39, v39
    v_exp_f32 v40, v40
    v_mfma_f32_32x32x16_bf16 v[20:35], v[132:135], v[240:243], 0
    v_exp_f32 v41, v41
    v_exp_f32 v42, v42
    v_exp_f32 v43, v43
    v_exp_f32 v44, v44
    v_exp_f32 v45, v45
    v_exp_f32 v46, v46
    v_smfmac_f32_32x32x32_bf16 v[72:87], v[172:175], v[36:43], v19
    ds_write_b32 v6, v70 offset:55296
    v_exp_f32 v47, v47
    v_exp_f32 v48, v48
    v_exp_f32 v49, v49
    v_exp_f32 v50, v50
    v_exp_f32 v51, v51
    v_exp_f32 v20, v20
    v_exp_f32 v21, v21
    v_smfmac_f32_32x32x32_bf16 v[72:87], v[176:179], v[44:51], v19
    v_exp_f32 v22, v22
    v_exp_f32 v23, v23
    v_exp_f32 v24, v24
    v_mfma_f32_32x32x16_bf16 v[36:51], v[136:139], v[240:243], 0
    v_exp_f32 v25, v25
    v_exp_f32 v26, v26
    v_exp_f32 v27, v27
    v_exp_f32 v28, v28
    v_exp_f32 v29, v29
    v_exp_f32 v30, v30
    v_smfmac_f32_32x32x32_bf16 v[72:87], v[180:183], v[20:27], v19
    v_exp_f32 v31, v31
    v_exp_f32 v32, v32
    v_exp_f32 v33, v33
    v_exp_f32 v34, v34
    v_exp_f32 v35, v35
    v_exp_f32 v36, v36
    v_exp_f32 v37, v37
    v_smfmac_f32_32x32x32_bf16 v[72:87], v[184:187], v[28:35], v19
    v_exp_f32 v38, v38
    v_exp_f32 v39, v39
    v_exp_f32 v40, v40
    v_mfma_f32_32x32x16_bf16 v[20:35], v[140:143], v[240:243], 0
    v_exp_f32 v41, v41
    v_exp_f32 v42, v42
    v_exp_f32 v43, v43
    v_exp_f32 v44, v44
    v_exp_f32 v45, v45
    v_exp_f32 v46, v46
    v_smfmac_f32_32x32x32_bf16 v[72:87], v[188:191], v[36:43], v19
    v_exp_f32 v47, v47
    v_exp_f32 v48, v48
    v_exp_f32 v49, v49
    v_exp_f32 v50, v50
    v_exp_f32 v51, v51
    v_exp_f32 v20, v20
    v_exp_f32 v21, v21
    v_smfmac_f32_32x32x32_bf16 v[72:87], v[192:195], v[44:51], v19
    v_exp_f32 v22, v22
    v_exp_f32 v23, v23
    v_exp_f32 v24, v24
    v_mfma_f32_32x32x16_bf16 v[36:51], v[144:147], v[240:243], 0
    v_exp_f32 v25, v25
    v_exp_f32 v26, v26
    v_exp_f32 v27, v27
    v_exp_f32 v28, v28
    v_exp_f32 v29, v29
    v_exp_f32 v30, v30
    v_smfmac_f32_32x32x32_bf16 v[72:87], v[196:199], v[20:27], v19
    v_exp_f32 v31, v31
    v_exp_f32 v32, v32
    v_exp_f32 v33, v33
    v_exp_f32 v34, v34
    v_exp_f32 v35, v35
    v_exp_f32 v36, v36
    v_exp_f32 v37, v37
    v_smfmac_f32_32x32x32_bf16 v[72:87], v[200:203], v[28:35], v19
    v_exp_f32 v38, v38
    v_exp_f32 v39, v39
    v_exp_f32 v40, v40
    v_exp_f32 v41, v41
    v_exp_f32 v42, v42
    v_exp_f32 v43, v43
    v_exp_f32 v44, v44
    v_exp_f32 v45, v45
    v_exp_f32 v46, v46
    v_smfmac_f32_32x32x32_bf16 v[72:87], v[204:207], v[36:43], v19
    v_exp_f32 v47, v47
    v_exp_f32 v48, v48
    v_exp_f32 v49, v49
    v_exp_f32 v50, v50
    v_exp_f32 v51, v51
    s_nop 3
    v_smfmac_f32_32x32x32_bf16 v[72:87], v[208:211], v[44:51], v19
    s_nop 11
    ds_write_b128 v4, v[72:75] offset:64512
    ds_write_b128 v5, v[76:79] offset:64512
    ds_write_b32 v6, v80 offset:64512
    s_waitcnt lgkmcnt(0)
    s_setprio 2
    s_barrier
    ds_read_b32 v156, v12 offset:2048
    ds_read_b32 v168, v12 offset:4352
    ds_read_b32 v180, v12 offset:6656
    ds_read_b32 v192, v12 offset:8960
    ds_read_b128 v[148:151], v11 offset:0
    ds_read_b128 v[152:155], v11 offset:1024
    ds_read_b128 v[160:163], v11 offset:2304
    ds_read_b128 v[164:167], v11 offset:3328
    ds_read_b128 v[172:175], v11 offset:4608
    ds_read_b128 v[176:179], v11 offset:5632
    ds_read_b128 v[184:187], v11 offset:6912
    ds_read_b128 v[188:191], v11 offset:7936
    s_waitcnt lgkmcnt(8)
    v_add_f32 v156, v156, v168
    v_add_f32 v180, v180, v192
    v_add_f32 v156, v156, v180
    v_rcp_f32 v158, v156
    s_waitcnt lgkmcnt(4)
    v_add_f32 v148, v148, v160
    v_add_f32 v149, v149, v161
    v_add_f32 v150, v150, v162
    v_add_f32 v151, v151, v163
    v_add_f32 v152, v152, v164
    v_add_f32 v153, v153, v165
    v_add_f32 v154, v154, v166
    v_add_f32 v155, v155, v167
    s_waitcnt lgkmcnt(2)
    v_add_f32 v148, v148, v172
    v_add_f32 v149, v149, v173
    v_add_f32 v150, v150, v174
    v_add_f32 v151, v151, v175
    v_add_f32 v152, v152, v176
    v_add_f32 v153, v153, v177
    v_add_f32 v154, v154, v178
    v_add_f32 v155, v155, v179
    s_waitcnt lgkmcnt(0)
    v_add_f32 v148, v148, v184
    v_add_f32 v149, v149, v185
    v_add_f32 v150, v150, v186
    v_add_f32 v151, v151, v187
    v_add_f32 v152, v152, v188
    v_add_f32 v153, v153, v189
    v_add_f32 v154, v154, v190
    v_add_f32 v155, v155, v191
    v_mul_f32 v2, 0, v148
    v_mul_f32 v3, 0, v149
    v_fma_f32 v2, v150, 0, v2
    v_fma_f32 v3, v151, 0, v3
    v_fma_f32 v2, v152, 0, v2
    v_fma_f32 v3, v153, 0, v3
    v_fma_f32 v2, v154, 0, v2
    v_fma_f32 v3, v155, 0, v3
    v_add_f32 v2, v2, v3
    v_add_f32 v2, v2, v156
    v_cmp_le_f32 vcc, 1.0, v2
    v_cmp_ge_f32 s[78:79], s21, v2
    v_mul_f32 v148, v148, v158
    v_mul_f32 v149, v149, v158
    v_mul_f32 v150, v150, v158
    v_mul_f32 v151, v151, v158
    v_mul_f32 v152, v152, v158
    v_mul_f32 v153, v153, v158
    v_mul_f32 v154, v154, v158
    v_mul_f32 v155, v155, v158
    s_and_b64 vcc, vcc, s[78:79]
    s_cmp_eq_u64 vcc, -1
    s_cbranch_scc1 L_ok12
    s_swappc_b64 s[6:7], s[8:9]
L_ok12:
    v_cvt_pk_bf16_f32 v160, v148, v149
    v_cvt_pk_bf16_f32 v161, v150, v151
    v_cvt_pk_bf16_f32 v162, v152, v153
    v_cvt_pk_bf16_f32 v163, v154, v155
    v_min_u32 v160, -2, v160
    v_min_u32 v161, -2, v161
    v_min_u32 v162, -2, v162
    v_min_u32 v163, -2, v163
    buffer_store_dwordx4 v[160:163], v17, s[44:47], s23 offen sc1
    buffer_load_dword v244, v16, s[44:47], s76 offen sc1
    ds_read_b64_tr_b16 v[20:21], v13 offset:0
    ds_read_b64_tr_b16 v[22:23], v13 offset:512
    v_mov_b32 v212, 0
    ds_read_b64_tr_b16 v[24:25], v13 offset:1024
    ds_read_b64_tr_b16 v[26:27], v13 offset:1536
    v_mov_b32 v213, 0
    ds_read_b64_tr_b16 v[28:29], v13 offset:2048
    ds_read_b64_tr_b16 v[30:31], v13 offset:2560
    v_mov_b32 v214, 0
    ds_read_b64_tr_b16 v[32:33], v13 offset:3072
    ds_read_b64_tr_b16 v[34:35], v13 offset:3584
    v_mov_b32 v215, 0
    ds_read_b64_tr_b16 v[36:37], v13 offset:4096
    ds_read_b64_tr_b16 v[38:39], v13 offset:4608
    v_mov_b32 v216, 0
    ds_read_b64_tr_b16 v[40:41], v13 offset:5120
    ds_read_b64_tr_b16 v[42:43], v13 offset:5632
    v_mov_b32 v217, 0
    s_waitcnt lgkmcnt(2)
    ds_read_b64_tr_b16 v[44:45], v13 offset:6144
    ds_read_b64_tr_b16 v[46:47], v13 offset:6656
    v_mov_b32 v218, 0
    ds_read_b64_tr_b16 v[48:49], v13 offset:7168
    ds_read_b64_tr_b16 v[50:51], v13 offset:7680
    v_mov_b32 v219, 0
    ds_read_b64_tr_b16 v[52:53], v13 offset:8192
    ds_read_b64_tr_b16 v[54:55], v13 offset:8704
    v_mov_b32 v220, 0
    ds_read_b64_tr_b16 v[56:57], v13 offset:9216
    ds_read_b64_tr_b16 v[58:59], v13 offset:9728
    v_mov_b32 v221, 0
    ds_read_b64_tr_b16 v[60:61], v13 offset:10240
    ds_read_b64_tr_b16 v[62:63], v13 offset:10752
    v_mov_b32 v222, 0
    s_waitcnt lgkmcnt(2)
    ds_read_b64_tr_b16 v[64:65], v13 offset:11264
    ds_read_b64_tr_b16 v[66:67], v13 offset:11776
    v_mov_b32 v223, 0
    ds_read_b64_tr_b16 v[68:69], v13 offset:12288
    ds_read_b64_tr_b16 v[70:71], v13 offset:12800
    v_mov_b32 v224, 0
    ds_read_b64_tr_b16 v[72:73], v13 offset:13312
    ds_read_b64_tr_b16 v[74:75], v13 offset:13824
    v_mov_b32 v225, 0
    ds_read_b64_tr_b16 v[76:77], v13 offset:14336
    ds_read_b64_tr_b16 v[78:79], v13 offset:14848
    v_mov_b32 v226, 0
    ds_read_b64_tr_b16 v[80:81], v13 offset:15360
    ds_read_b64_tr_b16 v[82:83], v13 offset:15872
    v_mov_b32 v227, 0
    buffer_load_dwordx4 v[84:87], v17, s[44:47], s72 offen offset:0 sc1
    buffer_load_dwordx4 v[88:91], v17, s[44:47], s72 offen offset:1024 sc1
    buffer_load_dwordx4 v[92:95], v17, s[44:47], s72 offen offset:2048 sc1
    buffer_load_dwordx4 v[96:99], v17, s[44:47], s72 offen offset:3072 sc1
    buffer_load_dwordx4 v[100:103], v17, s[44:47], s84 offen offset:0 sc1
    buffer_load_dwordx4 v[104:107], v17, s[44:47], s84 offen offset:1024 sc1
    buffer_load_dwordx4 v[108:111], v17, s[44:47], s84 offen offset:2048 sc1
    buffer_load_dwordx4 v[112:115], v17, s[44:47], s84 offen offset:3072 sc1
    buffer_load_dwordx4 v[116:119], v17, s[44:47], s85 offen offset:0 sc1
    buffer_load_dwordx4 v[120:123], v17, s[44:47], s85 offen offset:1024 sc1
    buffer_load_dwordx4 v[124:127], v17, s[44:47], s85 offen offset:2048 sc1
    buffer_load_dwordx4 v[128:131], v17, s[44:47], s85 offen offset:3072 sc1
    buffer_load_dwordx4 v[132:135], v17, s[44:47], s86 offen offset:0 sc1
    buffer_load_dwordx4 v[136:139], v17, s[44:47], s86 offen offset:1024 sc1
    buffer_load_dwordx4 v[140:143], v17, s[44:47], s86 offen offset:2048 sc1
    buffer_load_dwordx4 v[144:147], v17, s[44:47], s86 offen offset:3072 sc1
    s_mov_b32 s88, 0x100000
    s_mov_b32 s87, 15
    s_mov_b32 s80, 1
    s_waitcnt lgkmcnt(0)
L_yp:
    s_bitcmp1_b32 s87, 0
    s_cbranch_scc0 L_yn0
    s_waitcnt vmcnt(12)
    v_max3_u32 v2, v84, v85, v86
    v_max3_u32 v3, v87, v88, v89
    v_max3_u32 v2, v2, v90, v91
    v_max3_u32 v3, v3, v92, v93
    v_max3_u32 v2, v2, v94, v95
    v_max3_u32 v3, v3, v96, v97
    v_max3_u32 v2, v2, v98, v99
    v_max_u32 v2, v2, v3
    v_cmp_eq_u32 vcc, -1, v2
    s_cmp_eq_u64 vcc, 0
    s_cbranch_scc1 L_yg0
    buffer_load_dwordx4 v[84:87], v17, s[44:47], s72 offen offset:0 sc1
    buffer_load_dwordx4 v[88:91], v17, s[44:47], s72 offen offset:1024 sc1
    buffer_load_dwordx4 v[92:95], v17, s[44:47], s72 offen offset:2048 sc1
    buffer_load_dwordx4 v[96:99], v17, s[44:47], s72 offen offset:3072 sc1
    s_branch L_yn0
L_yg0:
    v_mfma_f32_32x32x16_bf16 v[212:227], v[20:23], v[84:87], v[212:227]
    v_mfma_f32_32x32x16_bf16 v[212:227], v[24:27], v[88:91], v[212:227]
    v_mfma_f32_32x32x16_bf16 v[212:227], v[28:31], v[92:95], v[212:227]
    v_mfma_f32_32x32x16_bf16 v[212:227], v[32:35], v[96:99], v[212:227]
    s_bitset0_b32 s87, 0
L_yn0:
    s_bitcmp1_b32 s87, 1
    s_cbranch_scc0 L_yn1
    s_waitcnt vmcnt(8)
    v_max3_u32 v2, v100, v101, v102
    v_max3_u32 v3, v103, v104, v105
    v_max3_u32 v2, v2, v106, v107
    v_max3_u32 v3, v3, v108, v109
    v_max3_u32 v2, v2, v110, v111
    v_max3_u32 v3, v3, v112, v113
    v_max3_u32 v2, v2, v114, v115
    v_max_u32 v2, v2, v3
    v_cmp_eq_u32 vcc, -1, v2
    s_cmp_eq_u64 vcc, 0
    s_cbranch_scc1 L_yg1
    buffer_load_dwordx4 v[100:103], v17, s[44:47], s84 offen offset:0 sc1
    buffer_load_dwordx4 v[104:107], v17, s[44:47], s84 offen offset:1024 sc1
    buffer_load_dwordx4 v[108:111], v17, s[44:47], s84 offen offset:2048 sc1
    buffer_load_dwordx4 v[112:115], v17, s[44:47], s84 offen offset:3072 sc1
    s_branch L_yn1
L_yg1:
    v_mfma_f32_32x32x16_bf16 v[212:227], v[36:39], v[100:103], v[212:227]
    v_mfma_f32_32x32x16_bf16 v[212:227], v[40:43], v[104:107], v[212:227]
    v_mfma_f32_32x32x16_bf16 v[212:227], v[44:47], v[108:111], v[212:227]
    v_mfma_f32_32x32x16_bf16 v[212:227], v[48:51], v[112:115], v[212:227]
    s_bitset0_b32 s87, 1
L_yn1:
    s_bitcmp1_b32 s87, 2
    s_cbranch_scc0 L_yn2
    s_waitcnt vmcnt(4)
    v_max3_u32 v2, v116, v117, v118
    v_max3_u32 v3, v119, v120, v121
    v_max3_u32 v2, v2, v122, v123
    v_max3_u32 v3, v3, v124, v125
    v_max3_u32 v2, v2, v126, v127
    v_max3_u32 v3, v3, v128, v129
    v_max3_u32 v2, v2, v130, v131
    v_max_u32 v2, v2, v3
    v_cmp_eq_u32 vcc, -1, v2
    s_cmp_eq_u64 vcc, 0
    s_cbranch_scc1 L_yg2
    buffer_load_dwordx4 v[116:119], v17, s[44:47], s85 offen offset:0 sc1
    buffer_load_dwordx4 v[120:123], v17, s[44:47], s85 offen offset:1024 sc1
    buffer_load_dwordx4 v[124:127], v17, s[44:47], s85 offen offset:2048 sc1
    buffer_load_dwordx4 v[128:131], v17, s[44:47], s85 offen offset:3072 sc1
    s_branch L_yn2
L_yg2:
    v_mfma_f32_32x32x16_bf16 v[212:227], v[52:55], v[116:119], v[212:227]
    v_mfma_f32_32x32x16_bf16 v[212:227], v[56:59], v[120:123], v[212:227]
    v_mfma_f32_32x32x16_bf16 v[212:227], v[60:63], v[124:127], v[212:227]
    v_mfma_f32_32x32x16_bf16 v[212:227], v[64:67], v[128:131], v[212:227]
    s_bitset0_b32 s87, 2
L_yn2:
    s_bitcmp1_b32 s87, 3
    s_cbranch_scc0 L_yn3
    s_waitcnt vmcnt(0)
    v_max3_u32 v2, v132, v133, v134
    v_max3_u32 v3, v135, v136, v137
    v_max3_u32 v2, v2, v138, v139
    v_max3_u32 v3, v3, v140, v141
    v_max3_u32 v2, v2, v142, v143
    v_max3_u32 v3, v3, v144, v145
    v_max3_u32 v2, v2, v146, v147
    v_max_u32 v2, v2, v3
    v_cmp_eq_u32 vcc, -1, v2
    s_cmp_eq_u64 vcc, 0
    s_cbranch_scc1 L_yg3
    buffer_load_dwordx4 v[132:135], v17, s[44:47], s86 offen offset:0 sc1
    buffer_load_dwordx4 v[136:139], v17, s[44:47], s86 offen offset:1024 sc1
    buffer_load_dwordx4 v[140:143], v17, s[44:47], s86 offen offset:2048 sc1
    buffer_load_dwordx4 v[144:147], v17, s[44:47], s86 offen offset:3072 sc1
    s_branch L_yn3
L_yg3:
    v_mfma_f32_32x32x16_bf16 v[212:227], v[68:71], v[132:135], v[212:227]
    v_mfma_f32_32x32x16_bf16 v[212:227], v[72:75], v[136:139], v[212:227]
    v_mfma_f32_32x32x16_bf16 v[212:227], v[76:79], v[140:143], v[212:227]
    v_mfma_f32_32x32x16_bf16 v[212:227], v[80:83], v[144:147], v[212:227]
    s_bitset0_b32 s87, 3
L_yn3:
    s_sub_u32 s88, s88, 1
    s_cselect_b32 s87, 0, s87
    s_cmp_eq_u32 s87, 0
    s_cbranch_scc1 L_ypd
    s_waitcnt vmcnt(0)
    s_branch L_yp
L_ypd:
    v_add_u32 v7, 27648, v9
    s_nop 6
    ds_write_b128 v8, v[212:215] offset:0
    ds_write_b128 v8, v[216:219] offset:32
    ds_write_b128 v8, v[220:223] offset:64
    ds_write_b128 v8, v[224:227] offset:96
L_tail:
    s_waitcnt lgkmcnt(0)
    s_barrier
    ds_read_b128 v[20:23], v9 offset:0
    ds_read_b128 v[24:27], v9 offset:16
    ds_read_b128 v[28:31], v9 offset:9216
    ds_read_b128 v[32:35], v9 offset:9232
    ds_read_b128 v[36:39], v7 offset:0
    ds_read_b128 v[40:43], v7 offset:16
    s_waitcnt lgkmcnt(2)
    v_pk_add_f32 v[20:21], v[20:21], v[28:29]
    v_pk_add_f32 v[22:23], v[22:23], v[30:31]
    v_pk_add_f32 v[24:25], v[24:25], v[32:33]
    v_pk_add_f32 v[26:27], v[26:27], v[34:35]
    s_waitcnt lgkmcnt(0)
    v_pk_fma_f32 v[20:21], v[20:21], v[244:245], v[36:37] op_sel:[0,0,0] op_sel_hi:[1,0,1]
    v_pk_fma_f32 v[22:23], v[22:23], v[244:245], v[38:39] op_sel:[0,0,0] op_sel_hi:[1,0,1]
    v_pk_fma_f32 v[24:25], v[24:25], v[244:245], v[40:41] op_sel:[0,0,0] op_sel_hi:[1,0,1]
    v_pk_fma_f32 v[26:27], v[26:27], v[244:245], v[42:43] op_sel:[0,0,0] op_sel_hi:[1,0,1]
    v_cvt_pk_bf16_f32 v28, v20, v21
    v_cvt_pk_bf16_f32 v29, v22, v23
    v_cvt_pk_bf16_f32 v30, v24, v25
    v_cvt_pk_bf16_f32 v31, v26, v27
    buffer_store_dwordx4 v[28:31], v10, s[52:55], s77 offen
    s_or_b32 s78, s2, s68
    s_cmp_lg_u32 s78, 0
    s_cbranch_scc1 L_noepoch
    s_mov_b64 exec, 1
    buffer_store_dwordx2 v[250:251], v252, s[44:47], 0 offen sc1
    s_mov_b64 exec, -1
L_noepoch:
L_end:
    s_endpgm
L_codeend:
L_slow:
    s_lshl_b32 s78, s74, 16
    s_lshl_b32 s79, s17, 10
    s_add_u32 s79, s79, s78
    s_add_u32 s79, s79, 1048576
    buffer_load_dwordx4 v[160:163], v17, s[44:47], s79 offen sc1
    s_add_u32 s79, s78, 3145728
    s_mov_b32 s80, 64
    v_mov_b32 v232, 0xff7fffff
L_slow1:
    buffer_load_dwordx4 v[164:167], v17, s[44:47], s79 offen sc1
    s_waitcnt vmcnt(0)
    v_mfma_f32_32x32x16_bf16 v[176:191], v[164:167], v[160:163], 0
    s_nop 11
    v_max3_f32 v232, v232, v176, v177
    v_max3_f32 v232, v232, v178, v179
    v_max3_f32 v232, v232, v180, v181
    v_max3_f32 v232, v232, v182, v183
    v_max3_f32 v232, v232, v184, v185
    v_max3_f32 v232, v232, v186, v187
    v_max3_f32 v232, v232, v188, v189
    v_max3_f32 v232, v232, v190, v191
    s_add_u32 s79, s79, 1024
    s_sub_u32 s80, s80, 1
    s_cmp_lg_u32 s80, 0
    s_cbranch_scc1 L_slow1
    v_mov_b32 v233, v232
    s_nop 1
    v_permlane32_swap_b32 v232, v233
    v_max_f32 v232, v232, v233
    v_sub_f32 v216, 0, v232
    v_sub_f32 v217, 0, v232
    v_sub_f32 v218, 0, v232
    v_sub_f32 v219, 0, v232
    v_sub_f32 v220, 0, v232
    v_sub_f32 v221, 0, v232
    v_sub_f32 v222, 0, v232
    v_sub_f32 v223, 0, v232
    v_sub_f32 v224, 0, v232
    v_sub_f32 v225, 0, v232
    v_sub_f32 v226, 0, v232
    v_sub_f32 v227, 0, v232
    v_sub_f32 v228, 0, v232
    v_sub_f32 v229, 0, v232
    v_sub_f32 v230, 0, v232
    v_sub_f32 v231, 0, v232
    v_mov_b32 v200, 0
    v_mov_b32 v201, 0
    v_mov_b32 v202, 0
    v_mov_b32 v203, 0
    v_mov_b32 v204, 0
    v_mov_b32 v205, 0
    v_mov_b32 v206, 0
    v_mov_b32 v207, 0
    v_mov_b32 v208, 0
    v_mov_b32 v209, 0
    v_mov_b32 v210, 0
    v_mov_b32 v211, 0
    v_mov_b32 v212, 0
    v_mov_b32 v213, 0
    v_mov_b32 v214, 0
    v_mov_b32 v215, 0
    v_mov_b32 v168, 0x3f803f80
    v_mov_b32 v169, 0x3f803f80
    v_mov_b32 v170, 0x3f803f80
    v_mov_b32 v171, 0x3f803f80
    v_mov_b32 v172, 0x3f803f80
    v_mov_b32 v173, 0x3f803f80
    v_mov_b32 v174, 0x3f803f80
    v_mov_b32 v175, 0x3f803f80
    s_add_u32 s79, s78, 3145728
    s_add_u32 s81, s78, 5242880
    s_mov_b32 s80, 64
L_slow2:
    buffer_load_dwordx4 v[164:167], v17, s[44:47], s79 offen sc1
    s_mov_b64 exec, s[4:5]
    buffer_load_dwordx4 v[168:171], v255, s[44:47], s81 offen sc1
    buffer_load_dwordx4 v[172:175], v255, s[44:47], s81 offen offset:512 sc1
    s_mov_b64 exec, -1
    s_waitcnt vmcnt(0)
    v_mfma_f32_32x32x16_bf16 v[176:191], v[164:167], v[160:163], v[216:231]
    s_nop 11
    v_exp_f32 v176, v176
    v_exp_f32 v177, v177
    v_exp_f32 v178, v178
    v_exp_f32 v179, v179
    v_exp_f32 v180, v180
    v_exp_f32 v181, v181
    v_exp_f32 v182, v182
    v_exp_f32 v183, v183
    v_exp_f32 v184, v184
    v_exp_f32 v185, v185
    v_exp_f32 v186, v186
    v_exp_f32 v187, v187
    v_exp_f32 v188, v188
    v_exp_f32 v189, v189
    v_exp_f32 v190, v190
    v_exp_f32 v191, v191
    v_cvt_pk_bf16_f32 v192, v176, v177
    v_cvt_pk_bf16_f32 v193, v178, v179
    v_cvt_pk_bf16_f32 v194, v180, v181
    v_cvt_pk_bf16_f32 v195, v182, v183
    v_cvt_pk_bf16_f32 v196, v184, v185
    v_cvt_pk_bf16_f32 v197, v186, v187
    v_cvt_pk_bf16_f32 v198, v188, v189
    v_cvt_pk_bf16_f32 v199, v190, v191
    v_mfma_f32_32x32x16_bf16 v[200:215], v[168:171], v[192:195], v[200:215]
    s_nop 0
    v_mfma_f32_32x32x16_bf16 v[200:215], v[172:175], v[196:199], v[200:215]
    s_add_u32 s79, s79, 1024
    s_add_u32 s81, s81, 1024
    s_sub_u32 s80, s80, 1
    s_nop 7
    s_cmp_lg_u32 s80, 0
    s_cbranch_scc1 L_slow2
    v_rcp_f32 v208, v208
    s_nop 0
    v_mul_f32 v148, v200, v208
    v_mul_f32 v149, v201, v208
    v_mul_f32 v150, v202, v208
    v_mul_f32 v151, v203, v208
    v_mul_f32 v152, v204, v208
    v_mul_f32 v153, v205, v208
    v_mul_f32 v154, v206, v208
    v_mul_f32 v155, v207, v208
    s_setpc_b64 s[6:7]
    s_endpgm
.section .rodata,"a"
.p2align 6
.amdhsa_kernel gated_mix__mha_block__linear_kernel_hedgehog__prompt_kernel
  .amdhsa_next_free_vgpr 256
  .amdhsa_next_free_sgpr 102
  .amdhsa_accum_offset 256
  .amdhsa_group_segment_fixed_size 0
  .amdhsa_kernarg_size 88
  .amdhsa_user_sgpr_count 2
  .amdhsa_user_sgpr_kernarg_segment_ptr 1
  .amdhsa_system_sgpr_workgroup_id_x 1
.end_amdhsa_kernel
```
